```python
import torch

def _softmax(x, axis=-1):
    return torch.softmax(x, dim=axis)
def _gelu(x):
    return torch.nn.functional.gelu(x, approximate="tanh")
def _silu(x):
    return torch.nn.functional.silu(x)
def _sigmoid(x):
    return torch.sigmoid(x)
def _layernorm(x, axis=-1, eps=1e-5):
    m = x.mean(dim=axis, keepdim=True)
    v = x.var(dim=axis, keepdim=True, unbiased=False)
    return (x - m) / torch.sqrt(v + eps)
def _scatter_add(tgt, idx, src, axis=0):
    return tgt.clone().index_add_(axis, idx, src)
def _segment_sum(src, seg, n):
    out = torch.zeros((n,) + src.shape[1:], dtype=src.dtype)
    return out.index_add_(0, seg, src)
def _pad(x, pw):
    flat = tuple(v for pair in reversed(pw) for v in pair)
    return torch.nn.functional.pad(x, flat)

kernel_name = 'sequential_preLN__sliding_block_cached__dense_activation_squared_relu__decode'

def setup_inputs():

    _w = (lambda a: (lambda t: t.to(torch.bfloat16) if t.is_floating_point() else t)(torch.as_tensor(a)))
    def _A_setup():
        B, Sq, D = 1, 1, 512
        Hq, Hkv, Sk, Dh = 32, 8, 65536, 128
        assert Hq % Hkv == 0, (Hq, Hkv)
        return {
            "x": _w((lambda *s: torch.randn(*s, dtype=torch.bfloat16) * 0.05)(B, Sq, D)),
            "k_cache": _w((lambda *s: torch.randn(*s, dtype=torch.bfloat16) * 3.2)(B, Hkv, Sk, Dh)),
            "v_cache": _w((lambda *s: torch.randn(*s, dtype=torch.bfloat16) * 0.4)(B, Hkv, Sk, Dh)),
            "wq": _w((lambda *s: torch.randn(*s, dtype=torch.bfloat16) * 3.2)(D, Hq * Dh) * (D ** -0.5)),
            "wo": _w((lambda *s: torch.randn(*s, dtype=torch.bfloat16) * 0.4)(Hq * Dh, D) * ((Hq * Dh) ** -0.5)),
        }
    _A_in = _A_setup()

    def _B_setup():
        B, S, D, F = 1, 1, 512, 1792
        return {
            "x": _w((lambda *s: torch.randn(*s, dtype=torch.bfloat16) * 0.05)(B, S, D)),
            "w1": _w((lambda *s: torch.randn(*s, dtype=torch.bfloat16) * 0.05)(D, F)),
            "b1": _w((lambda *s: torch.randn(*s, dtype=torch.bfloat16) * 0.8)(F)),
            "w2": _w((lambda *s: torch.randn(*s, dtype=torch.bfloat16) * 0.05)(F, D)),
            "b2": _w((lambda *s: torch.randn(*s, dtype=torch.bfloat16) * 1.6)(D)),
        }
    _B_in = _B_setup()

    return {
        "A_x": _A_in["x"],
        "A_k_cache": _A_in["k_cache"],
        "A_v_cache": _A_in["v_cache"],
        "A_wq": _A_in["wq"],
        "A_wo": _A_in["wo"],
        "B_x": _B_in["x"],
        "B_w1": _B_in["w1"],
        "B_b1": _B_in["b1"],
        "B_w2": _B_in["w2"],
        "B_b2": _B_in["b2"],
    }

def reference(A_x, A_k_cache, A_v_cache, A_wq, A_wo, B_x, B_w1, B_b1, B_w2, B_b2):
    def _A_ref(x, k_cache, v_cache, wq, wo):
        B, Sq, D = x.shape
        Hq, Dh = 32, 128
        Hkv, Sk = k_cache.shape[1], k_cache.shape[2]
        W = min(4096, max(256, Sk // 4))
        rep = Hq // Hkv
        q = (lambda x, *d: x.permute(*d))((x @ wq).reshape(B, Sq, Hq, Dh), 0, 2, 1, 3)
        k = (lambda x, n, axis: torch.repeat_interleave(x, n, dim=axis))(k_cache[:, :, Sk - W:, :], rep, axis=1)
        v = (lambda x, n, axis: torch.repeat_interleave(x, n, dim=axis))(v_cache[:, :, Sk - W:, :], rep, axis=1)
        scores = torch.einsum("bhqd,bhkd->bhqk", q, k) * (Dh ** -0.5)
        p = _softmax(scores, axis=-1)
        o = torch.einsum("bhqk,bhkd->bhqd", p, v)
        return (lambda x, *d: x.permute(*d))(o, 0, 2, 1, 3).reshape(B, Sq, Hq * Dh) @ wo

    def _B_ref(x, w1, b1, w2, b2):
        h = torch.einsum("bsd,df->bsf", x, w1) + b1
        zero = torch.zeros_like(h)
        r = torch.where(h > zero, h, zero)
        h = r * r
        out = torch.einsum("bsf,fd->bsd", h, w2) + b2
        return out

    x = A_x
    h = x + _A_ref(_layernorm(x, axis=-1), A_k_cache, A_v_cache, A_wq, A_wo)
    h2 = h + _B_ref(_layernorm(h, axis=-1), B_w1, B_b1, B_w2, B_b2)
    return h2
```

```asm
; @launch grid=(256,1,1) block=(512,1,1) lds=13824
.amdgcn_target "amdgcn-amd-amdhsa--gfx950"
.text
.p2align 12
.fill 832, 4, 0xbf810000
.globl sequential_preLN__sliding_block_cached__dense_activation_squared_relu__decode_kernel
.p2align 8
.type sequential_preLN__sliding_block_cached__dense_activation_squared_relu__decode_kernel,@function
sequential_preLN__sliding_block_cached__dense_activation_squared_relu__decode_kernel:
    s_load_dwordx16 s[4:19], s[0:1], 0
    s_load_dwordx8 s[20:27], s[0:1], 64
    s_load_dwordx2 s[28:29], s[0:1], 96
    s_cmp_ge_u32 s2, 256
    s_cbranch_scc1 L_exit
    v_lshrrev_b32 v2, 6, v0
    v_and_b32 v1, 63, v0
    v_readfirstlane_b32 s3, v2
    s_and_b32 s30, s2, 7
    s_lshr_b32 s31, s2, 3
    s_mov_b32 s36, 0x100000
    s_add_u32 s91, s2, 7
    s_and_b32 s91, s91, 7
    v_lshrrev_b32 v4, 4, v1
    s_cmp_ge_u32 s3, 4
    s_cbranch_scc1 L_A
    s_cmp_lg_u32 s3, 0
    s_cbranch_scc1 L_W
    s_getpc_b64 s[40:41]
    s_and_b32 s40, s40, 0xfffff000
    s_lshl_b32 s38, s31, 7
    v_lshl_add_u32 v2, v1, 12, s38
    s_mov_b64 exec, 7
    global_load_dword v127, v2, s[40:41]
    s_lshl_b32 s38, s31, 8
    v_lshl_add_u32 v2, v1, 7, s38
    s_lshl_b32 s38, s31, 3
    s_add_u32 s38, s38, 0x2000
    v_writelane_b32 v2, s38, 2
    s_lshl_b32 s38, s30, 15
    s_add_u32 s38, s38, 0x10000
    v_add_u32 v2, s38, v2
    s_waitcnt lgkmcnt(0)
    global_load_dword v126, v2, s[28:29]
    s_mov_b64 exec, -1
    s_branch L_W
L_A:
    v_lshlrev_b32 v6, 16, v4
    v_bfe_u32 v7, v1, 3, 1
    v_lshl_add_u32 v6, v7, 13, v6
    v_and_b32 v3, 7, v1
    v_lshl_add_u32 v6, v3, 4, v6
    s_and_b32 s45, s3, 3
    s_lshr_b32 s57, s31, 3
    s_lshl_b32 s57, s57, 2
    s_add_u32 s57, s57, s45
    s_and_b32 s58, s31, 7
    s_lshl_b32 s38, s57, 18
    s_lshl_b32 s39, s30, 10
    s_add_u32 s38, s38, s39
    s_lshl_b32 s39, s58, 7
    s_add_u32 s38, s38, s39
    s_mov_b32 s40, s38
    s_lshl_b32 s39, s57, 6
    v_and_b32 v9, 3, v1
    v_lshl_add_u32 v9, v4, 2, v9
    v_lshl_add_u32 v9, v9, 2, s39
    v_lshlrev_b32 v14, 4, v1
    s_movk_i32 s41, 0x4000
    s_lshl_b32 s42, s41, 1
    s_add_u32 s43, s41, s42
    s_mov_b32 s94, 254080
    s_mov_b32 s95, 0x20000
    s_nop 0
    s_waitcnt lgkmcnt(0)
    s_add_u32 s92, s10, s40
    s_addc_u32 s93, s11, 0
    buffer_load_dwordx4 v[64:67], v6, s[92:95], 0 offen nt
    buffer_load_dwordx4 v[68:71], v6, s[92:95], s41 offen nt
    global_load_dwordx4 v[96:99], v14, s[4:5]
    global_load_dword v8, v9, s[4:5]
    s_load_dword s32, s[28:29], 0
    v_and_b32 v5, 1, v1
    v_lshlrev_b32 v10, 4, v5
    v_bfe_u32 v3, v1, 1, 3
    buffer_load_dwordx4 v[72:75], v6, s[92:95], s42 offen nt
    buffer_load_dwordx4 v[76:79], v6, s[92:95], s43 offen nt
    v_lshl_add_u32 v2, v3, 8, v10
    v_lshl_add_u32 v2, v4, 5, v2
    s_mul_i32 s56, s45, 10
    s_add_u32 s56, s56, s31
    s_add_u32 s59, s56, 5
    s_and_b32 s56, s56, 31
    s_and_b32 s59, s59, 31
    s_sub_u32 s59, s59, s56
    s_add_u32 s59, s59, 32
    s_lshl_b32 s59, s59, 12
    v_add_u32 v21, s59, v2
    s_lshl_b32 s38, s30, 24
    s_lshl_b32 s39, s45, 18
    s_add_u32 s38, s38, s39
    s_lshl_b32 s39, s56, 12
    s_add_u32 s38, s38, s39
    s_add_u32 s38, s38, 0xf00000
    s_add_u32 s6, s6, s38
    s_addc_u32 s7, s7, 0
    s_add_u32 s8, s8, s38
    s_addc_u32 s9, s9, 0
    v_mul_u32_u24 v7, 0x0202, v7
    v_add_u32 v7, 0x0100, v7
    v_lshlrev_b32 v7, v10, v7
    v_mov_b32 v11, 0x0c0c0000
    v_lshrrev_b32 v11, v10, v11
    v_or_b32 v7, v7, v11
    v_mov_b32 v11, 0x0c0c0c0c
    v_and_b32 v3, 3, v3
    v_cmp_eq_u32 vcc, 0, v3
    s_nop 1
    v_cndmask_b32 v104, v11, v7, vcc
    v_cmp_eq_u32 vcc, 1, v3
    s_nop 1
    v_cndmask_b32 v105, v11, v7, vcc
    v_cmp_eq_u32 vcc, 2, v3
    s_nop 1
    v_cndmask_b32 v106, v11, v7, vcc
    v_cmp_eq_u32 vcc, 3, v3
    s_nop 1
    v_cndmask_b32 v107, v11, v7, vcc
    s_lshl_b32 s38, s45, 10
    s_add_u32 s38, s38, 0x2000
    v_add_u32 v18, s38, v14
    global_load_dwordx4 v[32:35], v2, s[6:7] offset:0 nt
    global_load_dwordx4 v[36:39], v2, s[6:7] offset:128 nt
    s_waitcnt vmcnt(4)
    global_load_dwordx4 v[40:43], v2, s[6:7] offset:2048 nt
    global_load_dwordx4 v[44:47], v2, s[6:7] offset:2176 nt
    v_lshlrev_b32 v24, 16, v96
    v_and_b32 v25, 0xffff0000, v96
    v_lshlrev_b32 v26, 16, v97
    v_and_b32 v27, 0xffff0000, v97
    v_lshlrev_b32 v28, 16, v98
    v_and_b32 v29, 0xffff0000, v98
    v_lshlrev_b32_e64 v30, 16, v99
    v_and_b32 v31, 0xffff0000, v99
    v_pk_add_f32 v[12:13], v[24:25], v[26:27]
    v_pk_add_f32 v[16:17], v[28:29], v[30:31]
    v_pk_add_f32 v[12:13], v[12:13], v[16:17]
    v_add_f32 v12, v12, v13
    s_nop 1
    v_add_f32_dpp v12, v12, v12 quad_perm:[1,0,3,2] row_mask:0xf bank_mask:0xf
    s_nop 1
    v_add_f32_dpp v12, v12, v12 quad_perm:[2,3,0,1] row_mask:0xf bank_mask:0xf
    s_nop 1
    v_add_f32_dpp v12, v12, v12 row_half_mirror row_mask:0xf bank_mask:0xf
    s_nop 1
    v_add_f32_dpp v12, v12, v12 row_mirror row_mask:0xf bank_mask:0xf
    v_mov_b32 v13, v12
    s_nop 1
    v_permlane16_swap_b32 v13, v12
    v_add_f32 v12, v12, v13
    v_mov_b32 v13, v12
    s_nop 1
    v_permlane32_swap_b32 v13, v12
    v_add_f32_e64 v12, v12, v13
    v_mul_f32 v12, 0x3b000000, v12
    v_pk_add_f32 v[24:25], v[24:25], v[12:13] op_sel_hi:[1,0] neg_lo:[0,1] neg_hi:[0,1]
    v_pk_add_f32 v[26:27], v[26:27], v[12:13] op_sel_hi:[1,0] neg_lo:[0,1] neg_hi:[0,1]
    v_pk_add_f32 v[28:29], v[28:29], v[12:13] op_sel_hi:[1,0] neg_lo:[0,1] neg_hi:[0,1]
    v_pk_add_f32 v[30:31], v[30:31], v[12:13] op_sel_hi:[1,0] neg_lo:[0,1] neg_hi:[0,1]
    v_pk_mul_f32 v[16:17], v[24:25], v[24:25]
    v_pk_fma_f32 v[16:17], v[26:27], v[26:27], v[16:17]
    v_pk_fma_f32 v[16:17], v[28:29], v[28:29], v[16:17]
    v_pk_fma_f32 v[16:17], v[30:31], v[30:31], v[16:17]
    v_add_f32 v16, v16, v17
    s_nop 1
    v_add_f32_dpp v16, v16, v16 quad_perm:[1,0,3,2] row_mask:0xf bank_mask:0xf
    s_nop 1
    v_add_f32_dpp v16, v16, v16 quad_perm:[2,3,0,1] row_mask:0xf bank_mask:0xf
    s_nop 1
    v_add_f32_dpp v16, v16, v16 row_half_mirror row_mask:0xf bank_mask:0xf
    s_nop 1
    v_add_f32_dpp v16, v16, v16 row_mirror row_mask:0xf bank_mask:0xf
    v_mov_b32 v13, v16
    s_nop 1
    v_permlane16_swap_b32 v13, v16
    v_add_f32 v16, v16, v13
    v_mov_b32 v13, v16
    s_nop 1
    v_permlane32_swap_b32 v13, v16
    v_add_f32_e64 v16, v16, v13
    v_mul_f32 v16, 0x3b000000, v16
    v_cvt_pk_bf16_f32 v12, v12, v16
    v_and_b32 v16, 0xffff0000, v12
    v_lshlrev_b32 v12, 16, v12
    v_add_f32 v16, 0x3727c5ac, v16
    v_cvt_pk_bf16_f32 v16, v16, v16
    v_lshlrev_b32 v16, 16, v16
    v_sqrt_f32 v16, v16
    v_lshlrev_b32 v24, 16, v8
    v_and_b32 v25, 0xffff0000, v8
    v_cvt_pk_bf16_f32 v16, v16, v16
    v_lshlrev_b32 v16, 16, v16
    v_rcp_f32 v16, v16
    v_sub_f32 v24, v24, v12
    v_sub_f32 v25, v25, v12
    v_cvt_pk_bf16_f32 v24, v24, v25
    v_and_b32 v25, 0xffff0000, v24
    v_lshlrev_b32 v24, 16, v24
    v_mul_f32 v24, v24, v16
    v_mul_f32 v25, v25, v16
    v_cvt_pk_bf16_f32 v8, v24, v25
    s_nop 1
    v_mov_b32_dpp v9, v8 row_newbcast:0 row_mask:0xf bank_mask:0xf
    v_perm_b32 v24, v9, v9, v104
    v_perm_b32 v25, v9, v9, v105
    v_perm_b32 v26, v9, v9, v106
    v_perm_b32 v27, v9, v9, v107
    s_waitcnt vmcnt(7)
    s_nop 0
    v_mfma_f32_16x16x32_bf16 v[112:115], v[24:27], v[64:67], 0
    v_mov_b32_dpp v9, v8 row_newbcast:1 row_mask:0xf bank_mask:0xf
    v_perm_b32 v28, v9, v9, v104
    v_perm_b32 v29, v9, v9, v105
    v_perm_b32 v30, v9, v9, v106
    v_perm_b32 v31, v9, v9, v107
    s_waitcnt vmcnt(6)
    s_nop 0
    v_mfma_f32_16x16x32_bf16 v[112:115], v[28:31], v[68:71], v[112:115]
    v_mov_b32_dpp v9, v8 row_newbcast:2 row_mask:0xf bank_mask:0xf
    v_perm_b32 v24, v9, v9, v104
    v_perm_b32 v25, v9, v9, v105
    v_perm_b32 v26, v9, v9, v106
    v_perm_b32 v27, v9, v9, v107
    s_nop 0
    s_waitcnt vmcnt(5)
    global_load_dwordx4 v[48:51], v21, s[6:7] offset:0 nt
    v_mfma_f32_16x16x32_bf16 v[112:115], v[24:27], v[72:75], v[112:115]
    v_mov_b32_dpp v9, v8 row_newbcast:3 row_mask:0xf bank_mask:0xf
    v_perm_b32 v28, v9, v9, v104
    v_perm_b32 v29, v9, v9, v105
    v_perm_b32 v30, v9, v9, v106
    v_perm_b32 v31, v9, v9, v107
    s_waitcnt vmcnt(5)
    global_load_dwordx4 v[52:55], v21, s[6:7] offset:128 nt
    v_mfma_f32_16x16x32_bf16 v[112:115], v[28:31], v[76:79], v[112:115]
    v_and_b32 v3, 15, v1
    v_lshlrev_b32 v3, 4, v3
    v_lshl_add_u32 v3, v4, 9, v3
    v_add_u32 v22, s59, v3
    v_mov_b32 v7, 0xffff
    v_lshlrev_b32 v6, v10, v7
    v_and_b32 v7, 2, v1
    v_cmp_eq_u32 vcc, 0, v7
    ds_write_b128 v18, v[112:115]
    s_waitcnt lgkmcnt(0)
    s_barrier
    s_add_u32 s32, s32, 0x6d2b79f5
    v_cndmask_b32 v10, 0, v6, vcc
    v_cndmask_b32 v11, v6, 0, vcc
    v_bfe_u32 v6, v1, 2, 2
    v_mul_u32_u24 v8, 320, v6
    v_lshl_add_u32 v8, v4, 5, v8
    v_lshl_add_u32 v8, v5, 4, v8
    v_mov_b32 v9, 1280
    v_cndmask_b32 v12, v9, v8, vcc
    v_cndmask_b32 v13, v8, v9, vcc
    s_cmp_eq_u32 s3, 7
    s_barrier
    global_load_dwordx4 v[56:59], v21, s[6:7] offset:2048 nt
    global_load_dwordx4 v[60:63], v21, s[6:7] offset:2176 nt
    s_cbranch_scc1 L_A7v
    s_setprio 1
    s_barrier
    s_barrier
    global_load_dwordx4 v[64:67], v3, s[8:9] offset:0 nt
    global_load_dwordx4 v[68:71], v3, s[8:9] offset:256 nt
    global_load_dwordx4 v[72:75], v3, s[8:9] offset:2048 nt
    global_load_dwordx4 v[76:79], v3, s[8:9] offset:2304 nt
    global_load_dwordx4 v[80:83], v22, s[8:9] offset:0 nt
    global_load_dwordx4 v[84:87], v22, s[8:9] offset:256 nt
    s_barrier
    s_barrier
    global_load_dwordx4 v[88:91], v22, s[8:9] offset:2048 nt
    global_load_dwordx4 v[92:95], v22, s[8:9] offset:2304 nt
    s_branch L_Av
L_A7v:
    s_barrier
    s_barrier
    s_barrier
    s_barrier
    s_lshr_b32 s27, s31, 4
    s_cmp_eq_u32 s91, 7
    s_cselect_b32 s38, 2, 0
    s_add_u32 s27, s27, s38
    s_and_b32 s40, s31, 15
    global_load_dwordx4 v[64:67], v3, s[8:9] offset:0 nt
    global_load_dwordx4 v[68:71], v3, s[8:9] offset:256 nt
    global_load_dwordx4 v[72:75], v3, s[8:9] offset:2048 nt
    global_load_dwordx4 v[76:79], v3, s[8:9] offset:2304 nt
    global_load_dwordx4 v[80:83], v22, s[8:9] offset:0 nt
    global_load_dwordx4 v[84:87], v22, s[8:9] offset:256 nt
    global_load_dwordx4 v[88:91], v22, s[8:9] offset:2048 nt
    global_load_dwordx4 v[92:95], v22, s[8:9] offset:2304 nt
    s_setprio 1
L_Av:
    v_lshlrev_b32 v20, 14, v4
    v_lshl_add_u32 v20, v6, 12, v20
    v_lshl_add_u32 v20, v7, 6, v20
    v_lshl_add_u32 v20, v5, 4, v20
    s_lshr_b32 s56, s31, 2
    s_and_b32 s57, s31, 3
    s_lshl_b32 s38, s30, 16
    s_lshl_b32 s39, s56, 8
    s_add_u32 s38, s38, s39
    s_lshl_b32 s39, s57, 5
    s_add_u32 s38, s38, s39
    s_add_u32 s38, s38, 0x80000
    s_add_u32 s46, s28, s38
    s_addc_u32 s47, s29, 0
    v_cmp_eq_u32 s[54:55], 1, v5
    s_lshl_b32 s38, s45, 2
    v_lshl_add_u32 v15, v6, 4, s38
    s_cmp_eq_u32 s3, 7
    s_cselect_b32 s38, 28, s38
    v_mov_b32 v16, s38
    v_lshlrev_b32 v17, 4, v4
    s_lshl_b32 s38, s45, 11
    s_add_u32 s38, s38, 0x800
    v_add_u32 v19, s38, v14
    v_mov_b32 v18, 1
    v_mov_b32 v23, 0
    s_mov_b32 s56, 0x3db504f3
    s_mov_b32 s57, 0x3fb8aa3b
    s_mov_b32 s58, 0xffff0000
    s_lshr_b32 s27, s31, 4
    s_cmp_eq_u32 s91, 7
    s_cselect_b32 s38, 2, 0
    s_add_u32 s27, s27, s38
    s_and_b32 s40, s31, 15
    s_and_b32 s43, s32, 0xff
    s_bfe_u32 s33, s32, 0x80008
    s_bfe_u32 s34, s32, 0x80010
    s_lshr_b32 s35, s32, 24
    s_waitcnt vmcnt(8)
    s_barrier
    ds_read_b128 v[96:99], v12 offset:0
    ds_read_b128 v[100:103], v12 offset:128
    ds_read_b128 v[104:107], v13 offset:0
    ds_read_b128 v[108:111], v13 offset:128
    s_waitcnt lgkmcnt(3)
    v_mfma_f32_16x16x32_bf16 v[112:115], v[32:35], v[96:99], 0
    s_waitcnt lgkmcnt(2)
    v_mfma_f32_16x16x32_bf16 v[112:115], v[36:39], v[100:103], v[112:115]
    s_waitcnt lgkmcnt(1)
    v_mfma_f32_16x16x32_bf16 v[112:115], v[40:43], v[104:107], v[112:115]
    s_waitcnt lgkmcnt(0)
    v_mfma_f32_16x16x32_bf16 v[112:115], v[44:47], v[108:111], v[112:115]
    v_mfma_f32_16x16x32_bf16 v[116:119], v[48:51], v[96:99], 0
    v_mfma_f32_16x16x32_bf16 v[116:119], v[52:55], v[100:103], v[116:119]
    v_mfma_f32_16x16x32_bf16 v[116:119], v[56:59], v[104:107], v[116:119]
    v_mfma_f32_16x16x32_bf16 v[116:119], v[60:63], v[108:111], v[116:119]
    s_nop 3
    v_cndmask_b32 v113, v114, v113, s[54:55]
    v_cndmask_b32 v112, v112, v115, s[54:55]
    s_nop 0
    v_add_f32_dpp v114, v113, v112 quad_perm:[1,0,3,2] row_mask:0xf bank_mask:0xf
    v_cndmask_b32 v117, v118, v117, s[54:55]
    v_cndmask_b32 v116, v116, v119, s[54:55]
    s_nop 0
    v_add_f32_dpp v118, v117, v116 quad_perm:[1,0,3,2] row_mask:0xf bank_mask:0xf
    v_cvt_pk_bf16_f32 v5, v114, v118
    v_lshlrev_b32 v6, 16, v5
    v_and_b32 v7, s58, v5
    v_pk_mul_f32 v[6:7], v[6:7], s[56:57] op_sel_hi:[1,0]
    v_cvt_pk_bf16_f32 v5, v6, v7
    v_lshlrev_b32 v6, 16, v5
    v_and_b32 v7, s58, v5
    v_max_f32 v8, v6, v7
    s_nop 1
    v_max_f32_dpp v8, v8, v8 quad_perm:[1,0,3,2] row_mask:0xf bank_mask:0xf
    s_nop 1
    v_max_f32_dpp v9, v8, v8 quad_perm:[2,3,0,1] row_mask:0xf bank_mask:0xf
    v_max_f32_dpp v8, v8, v8 quad_perm:[2,3,0,1] row_mask:0xf bank_mask:0xf
    s_nop 1
    v_permlane16_swap_b32 v9, v8
    v_max_f32 v8, v8, v9
    v_mov_b32 v9, v8
    s_nop 1
    v_permlane32_swap_b32 v9, v8
    v_max_f32 v8, v8, v9
    v_pk_add_f32 v[6:7], v[6:7], v[8:9] op_sel_hi:[1,0] neg_lo:[0,1] neg_hi:[0,1]
    v_pk_mul_f32 v[6:7], v[6:7], s[56:57] op_sel:[0,1] op_sel_hi:[1,1]
    v_exp_f32 v6, v6
    v_exp_f32 v7, v7
    v_cvt_pk_bf16_f32 v12, v6, v6
    v_cvt_pk_bf16_f32 v13, v7, v7
    v_mul_f32 v8, s57, v8
    v_and_b32_dpp v32, v12, v10 quad_perm:[0,0,0,0] row_mask:0xf bank_mask:0xf
    v_and_b32_dpp v33, v12, v11 quad_perm:[0,0,0,0] row_mask:0xf bank_mask:0xf
    v_and_b32_dpp v34, v12, v10 quad_perm:[1,1,1,1] row_mask:0xf bank_mask:0xf
    v_and_b32_dpp v35, v12, v11 quad_perm:[1,1,1,1] row_mask:0xf bank_mask:0xf
    ds_write_b32 v15, v8 offset:1536
    ds_write_b32 v16, v18 offset:1504
    v_add_f32_e64 v5, v6, v7
    s_cmp_eq_u32 s3, 7
    s_waitcnt vmcnt(6)
    v_swap_b32 v66, v68
    v_swap_b32 v67, v69
    v_add_f32_dpp v5, v5, v5 quad_perm:[1,0,3,2] row_mask:0xf bank_mask:0xf
    v_and_b32_dpp v36, v12, v10 quad_perm:[2,2,2,2] row_mask:0xf bank_mask:0xf
    v_and_b32_dpp v37, v12, v11 quad_perm:[2,2,2,2] row_mask:0xf bank_mask:0xf
    v_mfma_f32_16x16x32_bf16 v[24:27], v[32:35], v[64:67], 0
    v_and_b32_dpp v38, v12, v10 quad_perm:[3,3,3,3] row_mask:0xf bank_mask:0xf
    v_and_b32_dpp v39, v12, v11 quad_perm:[3,3,3,3] row_mask:0xf bank_mask:0xf
    v_mfma_f32_16x16x32_bf16 v[28:31], v[32:35], v[68:71], 0
    s_nop 0
    s_waitcnt vmcnt(4)
    v_swap_b32 v74, v76
    v_swap_b32 v75, v77
    v_add_f32_dpp v9, v5, v5 quad_perm:[2,3,0,1] row_mask:0xf bank_mask:0xf
    v_add_f32_dpp v5, v5, v5 quad_perm:[2,3,0,1] row_mask:0xf bank_mask:0xf
    v_and_b32_dpp v40, v13, v10 quad_perm:[0,0,0,0] row_mask:0xf bank_mask:0xf
    v_and_b32_dpp v41, v13, v11 quad_perm:[0,0,0,0] row_mask:0xf bank_mask:0xf
    v_mfma_f32_16x16x32_bf16 v[24:27], v[36:39], v[72:75], v[24:27]
    v_and_b32_dpp v42, v13, v10 quad_perm:[1,1,1,1] row_mask:0xf bank_mask:0xf
    v_and_b32_dpp v43, v13, v11 quad_perm:[1,1,1,1] row_mask:0xf bank_mask:0xf
    v_mfma_f32_16x16x32_bf16 v[28:31], v[36:39], v[76:79], v[28:31]
    s_cbranch_scc1 L_A7
    s_waitcnt vmcnt(2)
    v_swap_b32 v82, v84
    v_swap_b32 v83, v85
    v_permlane16_swap_b32 v9, v5
    v_add_f32 v5, v5, v9
    v_mov_b32_e64 v9, v5
    v_and_b32_dpp v44, v13, v10 quad_perm:[2,2,2,2] row_mask:0xf bank_mask:0xf
    v_and_b32_dpp v45, v13, v11 quad_perm:[2,2,2,2] row_mask:0xf bank_mask:0xf
    v_mfma_f32_16x16x32_bf16 v[24:27], v[40:43], v[80:83], v[24:27]
    v_and_b32_dpp v46, v13, v10 quad_perm:[3,3,3,3] row_mask:0xf bank_mask:0xf
    v_and_b32_dpp v47, v13, v11 quad_perm:[3,3,3,3] row_mask:0xf bank_mask:0xf
    v_mfma_f32_16x16x32_bf16 v[28:31], v[40:43], v[84:87], v[28:31]
    s_waitcnt vmcnt(0)
    v_swap_b32 v90, v92
    v_swap_b32 v91, v93
    v_permlane32_swap_b32 v9, v5
    v_add_f32_e64 v5, v5, v9
    ds_write_b32 v15, v5 offset:1600
    v_mfma_f32_16x16x32_bf16 v[24:27], v[44:47], v[88:91], v[24:27]
    v_mfma_f32_16x16x32_bf16 v[28:31], v[44:47], v[92:95], v[28:31]
    s_setprio 0
    s_cmp_eq_u32 s27, 2
    s_nop 0
    s_nop 3
    ds_write_b128 v19, v[24:27]
    ds_write_b128 v19, v[28:31] offset:1024
    ds_write_b32 v16, v18 offset:1520
    s_cbranch_scc1 L_end
    s_barrier
    s_branch L_R
L_A7m:
    ds_read_b128 v[96:99], v23 offset:1504
    ds_read_b128 v[100:103], v17 offset:1536
    s_sub_u32 s36, s36, 1
    s_cbranch_scc1 L_end
    s_branch L_A7c
L_A7:
    ds_read_b128 v[96:99], v23 offset:1504
    ds_read_b128 v[100:103], v17 offset:1536
    s_waitcnt vmcnt(2)
    v_swap_b32 v82, v84
    v_swap_b32 v83, v85
    v_permlane16_swap_b32 v9, v5
    v_add_f32 v5, v5, v9
    v_mov_b32 v9, v5
    v_and_b32_dpp v44, v13, v10 quad_perm:[2,2,2,2] row_mask:0xf bank_mask:0xf
    v_and_b32_dpp v45, v13, v11 quad_perm:[2,2,2,2] row_mask:0xf bank_mask:0xf
    v_mfma_f32_16x16x32_bf16 v[24:27], v[40:43], v[80:83], v[24:27]
    v_and_b32_dpp v46, v13, v10 quad_perm:[3,3,3,3] row_mask:0xf bank_mask:0xf
    v_and_b32_dpp v47, v13, v11 quad_perm:[3,3,3,3] row_mask:0xf bank_mask:0xf
    v_mfma_f32_16x16x32_bf16 v[28:31], v[40:43], v[84:87], v[28:31]
    v_permlane32_swap_b32 v9, v5
    v_add_f32 v5, v5, v9
    ds_write_b32 v15, v5 offset:1600
L_A7c:
    s_waitcnt lgkmcnt(0)
    v_and_b32 v96, v96, v97
    v_bitop3_b32 v96, v96, v98, v99 bitop3:0x80
    v_cmp_ne_u32 vcc, 1, v96
    v_max3_f32 v50, v100, v101, v102
    v_max_f32 v50, v50, v103
    v_pk_add_f32 v[100:101], v[100:101], v[50:51] op_sel_hi:[1,0] neg_lo:[0,1] neg_hi:[0,1]
    v_pk_add_f32 v[102:103], v[102:103], v[50:51] op_sel_hi:[1,0] neg_lo:[0,1] neg_hi:[0,1]
    v_readfirstlane_b32 s37, v99
    s_cbranch_vccnz L_A7m
    v_exp_f32 v108, v100
    v_exp_f32 v109, v101
    v_exp_f32 v110, v102
    v_exp_f32 v111, v103
L_A7d:
    ds_read_b96 v[124:126], v23 offset:1520
    ds_read_b128 v[116:119], v14 offset:2048
    ds_read_b128 v[120:123], v14 offset:3072
    ds_read_b128 v[56:59], v14 offset:4096
    ds_read_b128 v[60:63], v14 offset:5120
    ds_read_b128 v[96:99], v14 offset:6144
    ds_read_b128 v[100:103], v14 offset:7168
    ds_read_b128 v[104:107], v17 offset:1600
    s_sub_u32 s36, s36, 1
    s_cbranch_scc1 L_end
    s_waitcnt lgkmcnt(7)
    v_bitop3_b32 v124, v124, v125, v126 bitop3:0x80
    v_cmp_ne_u32 vcc, 1, v124
    s_nop 0
    s_waitcnt lgkmcnt(5)
    v_pk_mul_f32 v[116:117], v[116:117], v[108:109] op_sel:[0,0] op_sel_hi:[1,0]
    v_pk_mul_f32 v[118:119], v[118:119], v[108:109] op_sel:[0,0] op_sel_hi:[1,0]
    v_pk_mul_f32 v[120:121], v[120:121], v[108:109] op_sel:[0,0] op_sel_hi:[1,0]
    v_pk_mul_f32 v[122:123], v[122:123], v[108:109] op_sel:[0,0] op_sel_hi:[1,0]
    s_bitcmp0_b32 s37, 1
    s_cbranch_vccnz L_A7d
    s_cbranch_scc1 L_slow0
    s_waitcnt vmcnt(0)
    v_swap_b32 v90, v92
    v_swap_b32 v91, v93
    v_mov_b32 v51, s32
    v_mov_b32 v55, s32
    v_mfma_f32_16x16x32_bf16 v[24:27], v[44:47], v[88:91], v[24:27]
    v_mfma_f32_16x16x32_bf16 v[28:31], v[44:47], v[92:95], v[28:31]
    s_nop 0
    s_waitcnt lgkmcnt(3)
    v_pk_fma_f32 v[116:117], v[56:57], v[108:109], v[116:117] op_sel:[0,1,0] op_sel_hi:[1,1,1]
    v_pk_fma_f32 v[118:119], v[58:59], v[108:109], v[118:119] op_sel:[0,1,0] op_sel_hi:[1,1,1]
    v_pk_fma_f32 v[120:121], v[60:61], v[108:109], v[120:121] op_sel:[0,1,0] op_sel_hi:[1,1,1]
    v_pk_fma_f32 v[122:123], v[62:63], v[108:109], v[122:123] op_sel:[0,1,0] op_sel_hi:[1,1,1]
    s_nop 0
    s_waitcnt lgkmcnt(0)
    v_pk_fma_f32 v[116:117], v[96:97], v[110:111], v[116:117] op_sel:[0,0,0] op_sel_hi:[1,0,1]
    v_pk_fma_f32 v[118:119], v[98:99], v[110:111], v[118:119] op_sel:[0,0,0] op_sel_hi:[1,0,1]
    v_pk_fma_f32 v[116:117], v[24:25], v[110:111], v[116:117] op_sel:[0,1,0] op_sel_hi:[1,1,1]
    v_pk_fma_f32 v[118:119], v[26:27], v[110:111], v[118:119] op_sel:[0,1,0] op_sel_hi:[1,1,1]
    v_cvt_pk_bf16_f32 v48, v116, v117
    v_cvt_pk_bf16_f32 v49, v118, v119
    global_store_dwordx4 v20, v[48:51], s[46:47]
    v_pk_fma_f32 v[120:121], v[100:101], v[110:111], v[120:121] op_sel:[0,0,0] op_sel_hi:[1,0,1]
    v_pk_fma_f32 v[122:123], v[102:103], v[110:111], v[122:123] op_sel:[0,0,0] op_sel_hi:[1,0,1]
    v_pk_fma_f32 v[120:121], v[28:29], v[110:111], v[120:121] op_sel:[0,1,0] op_sel_hi:[1,1,1]
    v_pk_fma_f32 v[122:123], v[30:31], v[110:111], v[122:123] op_sel:[0,1,0] op_sel_hi:[1,1,1]
    v_pk_mul_f32 v[104:105], v[104:105], v[108:109]
    v_pk_fma_f32 v[104:105], v[106:107], v[110:111], v[104:105]
    v_cvt_pk_bf16_f32 v52, v120, v121
    v_cvt_pk_bf16_f32 v53, v122, v123
    v_add_f32 v54, v104, v105
    global_store_dwordx4 v20, v[52:55], s[46:47] offset:2048
    s_barrier
    s_branch L_R7
L_Wx:
L_W:
    s_waitcnt lgkmcnt(0)
    s_load_dword s32, s[28:29], 0
    s_lshl_b32 s38, s30, 16
    s_lshl_b32 s39, s31, 11
    s_add_u32 s38, s38, s39
    s_lshl_b32 s39, s3, 9
    s_add_u32 s38, s38, s39
    s_add_u32 s38, s38, 0x80000
    s_add_u32 s50, s28, s38
    s_addc_u32 s51, s29, 0
    v_lshlrev_b32 v15, 7, v1
    s_getreg_b32 s59, hwreg(HW_REG_XCC_ID)
    v_lshrrev_b32 v5, 5, v1
    v_mov_b32 v14, 0xff
    v_mov_b32 v2, 0
    v_lshlrev_b32 v3, 2, v1
    ds_write_b32 v3, v2 offset:1280
    v_lshrrev_b32 v44, 3, v1
    v_and_b32 v45, 7, v1
    v_bfe_u32 v3, v1, 3, 1
    v_bfe_u32 v2, v1, 4, 1
    v_mul_u32_u24 v8, 640, v5
    v_lshl_add_u32 v8, v3, 8, v8
    v_lshl_add_u32 v8, v45, 4, v8
    v_lshl_add_u32 v8, v2, 3, v8
    v_add_u32 v8, 8192, v8
    v_lshl_add_u32 v11, v2, 1, v5
    v_lshlrev_b32 v9, 5, v45
    v_lshl_add_u32 v9, v3, 4, v9
    v_lshl_add_u32 v9, v11, 2, v9
    v_and_b32 v2, 31, v1
    v_lshlrev_b32 v6, 3, v2
    v_lshlrev_b32 v7, 4, v2
    v_lshl_add_u32 v7, v5, 11, v7
    s_lshl_b32 s38, s3, 9
    v_add_u32 v7, s38, v7
    v_lshl_add_u32 v10, v5, 2, v6
    s_mul_i32 s38, s3, 320
    v_add_u32 v10, s38, v10
    v_add_u32 v6, 0x1000, v6
    s_lshl_b32 s38, s30, 15
    s_add_u32 s38, s38, 0x11000
    s_add_u32 s46, s28, s38
    s_addc_u32 s47, s29, 0
    v_lshlrev_b32 v2, 3, v11
    s_waitcnt lgkmcnt(0)
    s_add_u32 s32, s32, 0x6d2b79f5
    s_and_b32 s43, s32, 0xff
    s_bfe_u32 s33, s32, 0x80008
    s_bfe_u32 s34, s32, 0x80010
    s_lshr_b32 s35, s32, 24
    v_lshrrev_b32 v11, v2, s32
    s_cmp_lg_u32 s3, 0
    s_cbranch_scc1 L_W1
    s_lshl_b32 s38, s31, 3
    s_add_u32 s38, s38, 0x1000
    v_mov_b32 v2, s38
    v_add_u32 v3, 0x4000, v2
    v_mov_b32 v20, s59
    v_mov_b32 v21, s32
    s_mov_b64 exec, 1
    global_store_dwordx2 v2, v[20:21], s[46:47]
    global_store_dwordx2 v3, v[20:21], s[46:47] sc1
    s_mov_b64 exec, -1
    s_lshl_b32 s38, s31, 8
    v_add_u32 v2, s38, v9
    v_add_u32 v3, 0x4000, v2
    s_barrier
    ds_read2st64_b64 v[24:27], v8 offset0:0 offset1:2
    ds_read2st64_b64 v[28:31], v8 offset0:4 offset1:6
    s_waitcnt lgkmcnt(1)
    v_pk_add_f32 v[24:25], v[24:25], v[26:27]
    s_waitcnt lgkmcnt(0)
    v_pk_add_f32 v[28:29], v[28:29], v[30:31]
    v_pk_add_f32 v[24:25], v[24:25], v[28:29]
    s_nop 1
    v_permlane32_swap_b32 v24, v25
    v_add_f32_e64 v24, v24, v25
    v_add_u32 v24, 0x80, v24
    v_bfi_b32 v24, v14, v11, v24
    global_store_dword v2, v24, s[46:47] offset:-4096
    global_store_dword v3, v24, s[46:47] offset:-4096 sc1
    s_barrier
    s_barrier
    global_load_dwordx2 v[40:41], v6, s[46:47] sc1
    s_branch L_W2
L_W1:
    s_barrier
    s_barrier
    s_barrier
L_W2:
    s_mov_b64 exec, 15
    global_load_dword v125, v15, s[50:51]
    s_mov_b64 exec, -1
    global_load_dwordx4 v[32:35], v7, s[46:47] offset:-4096 sc1
    global_load_dwordx4 v[36:39], v7, s[46:47] sc1
    s_barrier
    s_barrier
    global_load_dwordx4 v[96:99], v7, s[46:47] offset:-4096 sc1
    global_load_dwordx4 v[100:103], v7, s[46:47] sc1
    s_barrier
    v_and_b32 v2, 1, v1
    v_lshlrev_b32 v2, 4, v2
    v_mov_b32 v3, 0xffff
    v_lshlrev_b32 v2, v2, v3
    v_bfe_u32 v3, v1, 1, 2
    v_cmp_eq_u32 vcc, 0, v3
    s_nop 1
    v_cndmask_b32 v16, 0, v2, vcc
    v_cmp_eq_u32 vcc, 1, v3
    s_nop 1
    v_cndmask_b32 v17, 0, v2, vcc
    v_cmp_eq_u32 vcc, 2, v3
    s_nop 1
    v_cndmask_b32 v18, 0, v2, vcc
    v_cmp_eq_u32 vcc, 3, v3
    s_nop 1
    v_cndmask_b32 v19, 0, v2, vcc
    s_and_b32 s40, s31, 3
    s_lshr_b32 s41, s31, 2
    s_lshl_b32 s38, s30, 2
    s_add_u32 s42, s38, s40
    s_lshl_b32 s38, s42, 17
    s_lshl_b32 s39, s3, 15
    s_add_u32 s38, s38, s39
    s_lshl_b32 s39, s41, 7
    s_add_u32 s38, s38, s39
    s_add_u32 s12, s12, s38
    s_addc_u32 s13, s13, 0
    v_lshlrev_b32 v47, 12, v44
    v_lshl_add_u32 v47, v45, 4, v47
    s_lshl_b32 s38, s30, 16
    s_lshl_b32 s39, s40, 14
    s_add_u32 s38, s38, s39
    s_lshl_b32 s39, s3, 12
    s_add_u32 s38, s38, s39
    s_add_u32 s38, s38, 0x80000
    s_add_u32 s48, s28, s38
    s_addc_u32 s49, s29, 0
    s_lshl_b32 s38, s41, 13
    s_lshl_b32 s39, s42, 7
    s_add_u32 s38, s38, s39
    s_add_u32 s38, s38, 0x100000
    s_add_u32 s52, s28, s38
    s_addc_u32 s53, s29, 0
    v_bfe_u32 v2, v1, 2, 2
    v_lshlrev_b32 v55, 8, v2
    v_lshl_add_u32 v55, v5, 7, v55
    v_and_b32 v2, 3, v1
    v_lshl_add_u32 v55, v2, 5, v55
    v_and_b32 v2, 16, v1
    v_add_u32_e64 v55, v55, v2
    s_lshl_b32 s38, s3, 10
    s_add_u32 s38, s38, 0x2000
    v_lshl_add_u32 v12, v1, 4, s38
    v_and_b32 v2, 0x7f, v9
    v_lshrrev_b32 v9, 7, v9
    v_lshl_add_u32 v9, v9, 12, v2
    s_mov_b32 s58, 0xffff0000
    s_lshr_b32 s27, s31, 4
    s_cmp_eq_u32 s91, 7
    s_cselect_b32 s38, 2, 0
    s_add_u32 s27, s27, s38
    s_and_b32 s40, s31, 15
    s_lshl_b32 s38, s40, 12
    s_lshl_b32 s39, s3, 10
    s_add_u32 s38, s38, s39
    s_add_u32 s38, s38, 0x100000
    s_add_u32 s6, s28, s38
    s_addc_u32 s7, s29, 0
    v_lshlrev_b32 v61, 4, v1
    v_lshl_add_u32 v62, v45, 2, v4
    s_lshl_b32 s38, s3, 2
    v_mov_b32 v13, s38
    v_mov_b32 v52, 0
    v_lshl_add_u32 v62, v62, 4, s38
    s_mov_b32 s44, 0
    s_waitcnt vmcnt(3)
    v_xor_b32 v32, s43, v32
    v_xor_b32 v33, s33, v33
    v_xor_b32 v34, s34, v34
    v_xor_b32 v35, s35, v35
    v_or3_b32 v42, v32, v33, v34
    s_waitcnt vmcnt(2)
    v_xor_b32 v36, s43, v36
    v_xor_b32 v37, s33, v37
    v_xor_b32 v38, s34, v38
    v_xor_b32 v39, s35, v39
    v_or3_b32 v42, v42, v35, v36
    v_or3_b32 v42, v42, v37, v38
    v_bitop3_b32 v42, v42, v39, v14 bitop3:0xa8
    v_cmp_ne_u32 vcc, 0, v42
    v_pk_add_f32 v[32:33], v[32:33], v[36:37]
    v_pk_add_f32 v[34:35], v[34:35], v[38:39]
    s_nop 1
    v_permlane32_swap_b32 v32, v34
    v_permlane32_swap_b32 v33, v35
    v_pk_add_f32 v[32:33], v[32:33], v[34:35]
    v_cvt_pk_bf16_f32 v43, v32, v33
    ds_write_b32 v10, v43 offset:0
    s_cbranch_vccz L_p1ok
    s_waitcnt vmcnt(1)
    v_xor_b32 v96, s43, v96
    v_xor_b32 v97, s33, v97
    v_xor_b32 v98, s34, v98
    v_xor_b32 v99, s35, v99
    v_or3_b32 v42, v96, v97, v98
    s_waitcnt vmcnt(0)
    v_xor_b32 v100, s43, v100
    v_xor_b32 v101, s33, v101
    v_xor_b32 v102, s34, v102
    v_xor_b32_e64 v103, s35, v103
    v_or3_b32 v42, v42, v99, v100
    v_or3_b32 v42, v42, v101, v102
    v_bitop3_b32 v42, v42, v103, v14 bitop3:0xa8
    v_cmp_ne_u32 vcc, 0, v42
    v_pk_add_f32 v[96:97], v[96:97], v[100:101]
    v_pk_add_f32 v[98:99], v[98:99], v[102:103]
    s_nop 1
    v_permlane32_swap_b32 v96, v98
    v_permlane32_swap_b32 v97, v99
    v_pk_add_f32 v[96:97], v[96:97], v[98:99]
    v_cvt_pk_bf16_f32 v43, v96, v97
    ds_write_b32 v10, v43 offset:0
    s_cbranch_vccnz L_p1
L_p1ok:
    s_waitcnt lgkmcnt(0)
    s_barrier
    s_cmp_lg_u32 s3, 0
    s_cbranch_scc1 L_xcd
L_xc:
    v_cmp_ne_u32 vcc, s32, v41
    v_cmp_ne_u32 s[56:57], s59, v40
    s_cbranch_vccnz L_xcr
    s_cmp_eq_u64 s[56:57], 0
    s_cselect_b32 s38, 3, 1
    v_mov_b32 v2, 0
    v_mov_b32 v3, s38
    ds_write_b32 v2, v3 offset:1516
L_xcd:
    s_cmp_lg_u32 s44, 0
    s_cbranch_scc1 L_wod
    s_waitcnt vmcnt(0)
    global_load_dwordx4 v[64:67], v47, s[12:13] offset:0 nt
    global_load_dwordx4 v[68:71], v47, s[12:13] offset:1024 nt
    global_load_dwordx4 v[72:75], v47, s[12:13] offset:2048 nt
    global_load_dwordx4 v[76:79], v47, s[12:13] offset:3072 nt
L_wod:
    s_waitcnt lgkmcnt(0)
    s_barrier
    s_setprio 1
    s_waitcnt vmcnt(0)
    s_mov_b64 vcc, -1
L_p2:
    s_mov_b64 exec, vcc
    global_load_dwordx4 v[32:35], v55, s[48:49] offset:0 sc1
    global_load_dwordx4 v[36:39], v55, s[48:49] offset:2048 sc1
    global_load_dwordx4 v[40:43], v55, s[48:49] offset:1024 sc1
    global_load_dwordx4 v[44:47], v55, s[48:49] offset:3072 sc1
    s_sub_u32 s36, s36, 1
    s_cbranch_scc1 L_end
    s_cmp_lg_u32 s3, 0
    s_waitcnt vmcnt(2)
    v_bitop3_b32 v48, v35, v39, s32 bitop3:0x7e
    v_lshlrev_b32 v96, 16, v32
    v_and_b32 v97, s58, v32
    v_lshlrev_b32 v98, 16, v33
    v_and_b32 v99, s58, v33
    s_waitcnt vmcnt(0)
    v_bitop3_b32 v49, v43, v47, s32 bitop3:0x7e
    v_or_b32 v49, v48, v49
    v_cmp_ne_u32 vcc, 0, v49
    v_max_f32 v48, v34, v42
    v_lshlrev_b32 v100, 16, v36
    v_and_b32 v101, s58, v36
    v_lshlrev_b32 v102, 16, v37
    v_and_b32 v103, s58, v37
    s_cbranch_vccnz L_p2
    s_mov_b64 exec, -1
    ds_write_b32 v13, v14 offset:1488
    v_max_f32_dpp v48, v48, v48 quad_perm:[1,0,3,2] row_mask:0xf bank_mask:0xf
    v_lshlrev_b32 v104, 16, v40
    v_and_b32 v105, s58, v40
    v_max_f32_dpp v48, v48, v48 quad_perm:[2,3,0,1] row_mask:0xf bank_mask:0xf
    v_lshlrev_b32 v106, 16, v41
    v_and_b32 v107, s58, v41
    v_max_f32_dpp v48, v48, v48 row_half_mirror row_mask:0xf bank_mask:0xf
    v_lshlrev_b32 v108, 16, v44
    v_and_b32 v109, s58, v44
    v_max_f32_dpp v48, v48, v48 row_mirror row_mask:0xf bank_mask:0xf
    v_sub_f32 v50, v34, v48
    v_exp_f32 v50, v50
    v_sub_f32 v51, v42, v48
    v_exp_f32 v51, v51
    v_lshlrev_b32 v110, 16, v45
    v_and_b32 v111, s58, v45
    v_pk_mul_f32 v[96:97], v[96:97], v[50:51] op_sel_hi:[1,0]
    v_pk_mul_f32 v[98:99], v[98:99], v[50:51] op_sel_hi:[1,0]
    v_pk_mul_f32 v[100:101], v[100:101], v[50:51] op_sel_hi:[1,0]
    v_pk_mul_f32 v[102:103], v[102:103], v[50:51] op_sel_hi:[1,0]
    v_pk_fma_f32 v[96:97], v[104:105], v[50:51], v[96:97] op_sel:[0,1,0] op_sel_hi:[1,1,1]
    v_pk_fma_f32 v[98:99], v[106:107], v[50:51], v[98:99] op_sel:[0,1,0] op_sel_hi:[1,1,1]
    v_pk_fma_f32 v[100:101], v[108:109], v[50:51], v[100:101] op_sel:[0,1,0] op_sel_hi:[1,1,1]
    v_pk_fma_f32 v[102:103], v[110:111], v[50:51], v[102:103] op_sel:[0,1,0] op_sel_hi:[1,1,1]
    v_add_f32_dpp v104, v96, v96 row_mirror row_mask:0xf bank_mask:0x3
    v_add_f32_dpp v105, v97, v97 row_mirror row_mask:0xf bank_mask:0x3
    v_add_f32_dpp v106, v98, v98 row_mirror row_mask:0xf bank_mask:0x3
    v_add_f32_dpp v107, v99, v99 row_mirror row_mask:0xf bank_mask:0x3
    v_add_f32_dpp v104, v100, v100 row_mirror row_mask:0xf bank_mask:0xc
    v_add_f32_dpp v105, v101, v101 row_mirror row_mask:0xf bank_mask:0xc
    v_add_f32_dpp v106, v102, v102 row_mirror row_mask:0xf bank_mask:0xc
    v_add_f32_dpp v107, v103, v103 row_mirror row_mask:0xf bank_mask:0xc
    v_add_f32_dpp v96, v104, v104 row_half_mirror row_mask:0xf bank_mask:0x5
    v_add_f32_dpp v97, v105, v105 row_half_mirror row_mask:0xf bank_mask:0x5
    v_mul_f32 v48, v50, v38
    v_add_f32_dpp v96, v106, v106 row_half_mirror row_mask:0xf bank_mask:0xa
    v_add_f32_dpp v97, v107, v107 row_half_mirror row_mask:0xf bank_mask:0xa
    v_fmac_f32 v48, v51, v46
    v_add_f32_dpp v96, v96, v96 quad_perm:[1,0,3,2] row_mask:0xf bank_mask:0xf
    v_add_f32_dpp v97, v97, v97 quad_perm:[1,0,3,2] row_mask:0xf bank_mask:0xf
    v_add_f32_dpp v48, v48, v48 quad_perm:[1,0,3,2] row_mask:0xf bank_mask:0xf
    v_add_f32_dpp v96, v96, v96 quad_perm:[2,3,0,1] row_mask:0xf bank_mask:0xf
    v_add_f32_dpp v97, v97, v97 quad_perm:[2,3,0,1] row_mask:0xf bank_mask:0xf
    v_cvt_pk_bf16_f32 v96, v96, v96
    v_cvt_pk_bf16_f32 v97, v97, v97
    v_add_f32_dpp v48, v48, v48 quad_perm:[2,3,0,1] row_mask:0xf bank_mask:0xf
    v_and_b32_dpp v24, v96, v16 quad_perm:[0,1,2,3] row_mask:0xf bank_mask:0xf
    v_and_b32_dpp v25, v96, v17 quad_perm:[0,1,2,3] row_mask:0xf bank_mask:0xf
    v_and_b32_dpp v26, v96, v18 row_half_mirror row_mask:0xf bank_mask:0xf
    v_and_b32_dpp v27, v96, v19 row_half_mirror row_mask:0xf bank_mask:0xf
    v_and_b32_dpp v28, v97, v16 quad_perm:[0,1,2,3] row_mask:0xf bank_mask:0xf
    v_and_b32_dpp v29, v97, v17 quad_perm:[0,1,2,3] row_mask:0xf bank_mask:0xf
    v_mfma_f32_16x16x32_bf16 v[20:23], v[24:27], v[64:67], 0
    v_and_b32_dpp v30, v97, v18 row_half_mirror row_mask:0xf bank_mask:0xf
    v_and_b32_dpp v31, v97, v19 row_half_mirror row_mask:0xf bank_mask:0xf
    v_and_b32_dpp v24, v96, v16 row_half_mirror row_mask:0xf bank_mask:0xf
    v_and_b32_dpp v25, v96, v17 row_half_mirror row_mask:0xf bank_mask:0xf
    v_mfma_f32_16x16x32_bf16 v[20:23], v[28:31], v[68:71], v[20:23]
    v_and_b32_dpp v26, v96, v18 quad_perm:[0,1,2,3] row_mask:0xf bank_mask:0xf
    v_and_b32_dpp v27, v96, v19 quad_perm:[0,1,2,3] row_mask:0xf bank_mask:0xf
    v_and_b32_dpp v28, v97, v16 row_half_mirror row_mask:0xf bank_mask:0xf
    v_and_b32_dpp v29, v97, v17 row_half_mirror row_mask:0xf bank_mask:0xf
    v_mfma_f32_16x16x32_bf16 v[20:23], v[24:27], v[72:75], v[20:23]
    v_and_b32_dpp v30, v97, v18 quad_perm:[0,1,2,3] row_mask:0xf bank_mask:0xf
    v_and_b32_dpp v31, v97, v19 quad_perm:[0,1,2,3] row_mask:0xf bank_mask:0xf
    v_add_f32_dpp v48, v48, v48 row_half_mirror row_mask:0xf bank_mask:0xf
    s_nop 0
    v_mfma_f32_16x16x32_bf16 v[20:23], v[28:31], v[76:79], v[20:23]
    v_add_f32_dpp v48, v48, v48 row_mirror row_mask:0xf bank_mask:0xf
    v_rcp_f32 v48, v48
    s_nop 5
    ds_write_b128 v12, v[20:23]
    s_mov_b64 exec, 1
    ds_add_rtn_u32 v49, v52, v14 offset:1472
    s_mov_b64 exec, -1
    ds_read2st64_b64 v[24:27], v8 offset0:0 offset1:2
    ds_read2st64_b64 v[28:31], v8 offset0:4 offset1:6
    s_waitcnt lgkmcnt(2)
    v_readfirstlane_b32 s38, v49
    s_waitcnt lgkmcnt(1)
    v_pk_add_f32 v[24:25], v[24:25], v[26:27]
    s_cmp_lg_u32 s38, 765
    s_waitcnt lgkmcnt(0)
    v_pk_add_f32 v[28:29], v[28:29], v[30:31]
    v_pk_add_f32 v[24:25], v[24:25], v[28:29]
    s_cbranch_scc1 L_wo2
    s_nop 0
    v_permlane32_swap_b32 v24, v25
    v_add_f32 v24, v24, v25
    v_mul_f32 v24, v24, v48
    v_bfi_b32 v24, v14, v11, v24
    global_store_dword v9, v24, s[52:53] sc1
L_wo2:
    s_cmp_lg_u32 s27, 1
    s_barrier
    s_cbranch_scc1 L_N
    s_barrier
L_p3:
    global_load_dwordx4 v[32:35], v61, s[6:7] sc1
    s_sub_u32 s36, s36, 1
    s_cbranch_scc1 L_end
    s_waitcnt vmcnt(0)
    v_xor_b32 v32, s43, v32
    v_xor_b32 v33, s33, v33
    v_xor_b32 v34, s34, v34
    v_xor_b32 v35, s35, v35
    v_or3_b32 v48, v32, v33, v34
    v_bitop3_b32 v48, v48, v35, v14 bitop3:0xa8
    v_cmp_ne_u32 vcc, 0, v48
    v_permlane32_swap_b32 v32, v34
    v_permlane32_swap_b32 v33, v35
    v_pk_add_f32 v[32:33], v[32:33], v[34:35]
    s_cbranch_vccnz L_p3
    s_nop 0
    v_permlane16_swap_b32 v32, v33
    v_add_f32 v32, v32, v33
    s_nop 1
    v_add_f32_dpp v32, v32, v32 row_ror:8 row_mask:0xf bank_mask:0xf
    ds_write_b32 v62, v32 offset:12288
    s_waitcnt lgkmcnt(0)
    s_barrier
    s_endpgm
L_N:
    s_cmp_eq_u32 s27, 3
    s_cbranch_scc1 L_fin
    s_add_u32 s38, s27, s3
    s_cmp_lt_u32 s38, 2
    s_cbranch_scc1 L_act
    s_waitcnt vmcnt(0)
    s_lshl_b32 s38, s27, 8
    s_or_b32 s38, s38, s31
    s_or_b32 s38, s38, s3
    s_cmp_lg_u32 s38, 0x200
    s_cbranch_scc1 L_end
    s_barrier
    buffer_wbl2 sc1
    s_endpgm
L_act:
    s_and_b32 s56, s40, 14
    s_add_u32 s56, s56, s3
    s_mul_i32 s38, s91, 0x9000
    s_lshl_b32 s39, s56, 11
    s_add_u32 s38, s38, s39
    s_add_u32 s38, s38, 0x110000
    s_add_u32 s6, s28, s38
    s_addc_u32 s7, s29, 0
    s_lshr_b32 s59, s40, 1
    s_mul_i32 s38, s91, 0x9000
    s_lshl_b32 s39, s59, 8
    s_add_u32 s38, s38, s39
    s_add_u32 s38, s38, 0x118000
    s_add_u32 s8, s28, s38
    s_addc_u32 s9, s29, 0
    v_lshrrev_b32 v62, 2, v1
    s_lshl_b32 s38, s91, 9
    s_lshl_b32 s39, s56, 5
    s_add_u32 s38, s38, s39
    v_lshl_add_u32 v60, v62, 1, s38
    s_lshl_b32 s38, s3, 6
    v_lshl_add_u32 v62, v62, 2, s38
    v_and_b32 v61, 15, v1
    v_lshlrev_b32 v55, 6, v61
    v_lshl_add_u32 v55, v4, 4, v55
    v_lshlrev_b32 v61, 4, v61
    global_load_ushort v60, v60, s[18:19]
    s_barrier
    s_mov_b64 vcc, -1
L_pcs:
    s_mov_b64 exec, vcc
    global_load_dwordx4 v[36:39], v55, s[6:7] offset:1024 sc1
    s_sub_u32 s36, s36, 1
    s_cbranch_scc1 L_end
    s_waitcnt vmcnt(0)
    v_xor_b32 v36, s43, v36
    v_xor_b32 v37, s33, v37
    v_xor_b32 v38, s34, v38
    v_xor_b32 v39, s35, v39
    v_or3_b32 v44, v36, v37, v38
    v_bitop3_b32 v44, v44, v39, v14 bitop3:0xa8
    v_cmp_ne_u32 vcc, 0, v44
    s_cbranch_vccnz L_pcs
    s_mov_b64 exec, -1
    global_load_dwordx4 v[40:43], v61, s[8:9] sc1
    global_load_dwordx4 v[32:35], v55, s[6:7] sc1
    v_add_f32_dpp v57, v36, v36 row_mirror row_mask:0xf bank_mask:0x3
    v_add_f32_dpp v58, v37, v37 row_mirror row_mask:0xf bank_mask:0x3
    s_nop 0
    v_add_f32_dpp v57, v38, v38 row_mirror row_mask:0xf bank_mask:0xc
    v_add_f32_dpp v58, v39, v39 row_mirror row_mask:0xf bank_mask:0xc
    s_nop 0
    v_add_f32_dpp v56, v57, v57 row_half_mirror row_mask:0xf bank_mask:0x5
    s_nop 1
    v_add_f32_dpp v56, v58, v58 row_half_mirror row_mask:0xf bank_mask:0xa
    s_nop 1
    v_add_f32_dpp v56, v56, v56 quad_perm:[1,0,3,2] row_mask:0xf bank_mask:0xf
    s_nop 1
    v_add_f32_dpp v56, v56, v56 quad_perm:[2,3,0,1] row_mask:0xf bank_mask:0xf
    v_lshlrev_b32 v60, 16, v60
    s_branch L_p3bc
L_p3b:
    global_load_dwordx4 v[40:43], v61, s[8:9] sc1
    global_load_dwordx4 v[32:35], v55, s[6:7] sc1
    s_sub_u32 s36, s36, 1
    s_cbranch_scc1 L_end
L_p3bc:
    s_waitcnt vmcnt(1)
    v_bitop3_b32 v43, v41, v43, s32 bitop3:0x7e
    v_add_f32_dpp v40, v40, v40 quad_perm:[1,0,3,2] row_mask:0xf bank_mask:0xf
    v_add_f32_dpp v42, v42, v42 quad_perm:[1,0,3,2] row_mask:0xf bank_mask:0xf
    s_waitcnt vmcnt(0)
    v_xor_b32 v32, s43, v32
    v_xor_b32 v33, s33, v33
    v_xor_b32 v34, s34, v34
    v_xor_b32 v35, s35, v35
    v_or3_b32 v45, v32, v33, v34
    v_bitop3_b32 v45, v45, v35, v14 bitop3:0xa8
    v_or_b32_e64 v45, v45, v43
    v_cmp_ne_u32 vcc, 0, v45
    v_add_f32_dpp v40, v40, v40 quad_perm:[2,3,0,1] row_mask:0xf bank_mask:0xf
    v_add_f32_dpp v42, v42, v42 quad_perm:[2,3,0,1] row_mask:0xf bank_mask:0xf
    v_add_f32_dpp v37, v32, v32 row_mirror row_mask:0xf bank_mask:0x3
    v_add_f32_dpp v40, v40, v40 row_half_mirror row_mask:0xf bank_mask:0xf
    v_add_f32_dpp v42, v42, v42 row_half_mirror row_mask:0xf bank_mask:0xf
    v_add_f32_dpp v38, v33, v33 row_mirror row_mask:0xf bank_mask:0x3
    s_cbranch_vccnz L_p3b
    s_barrier
    v_add_f32_dpp v40, v40, v40 row_mirror row_mask:0xf bank_mask:0xf
    v_add_f32_dpp v42, v42, v42 row_mirror row_mask:0xf bank_mask:0xf
    v_add_f32_dpp v37, v34, v34 row_mirror row_mask:0xf bank_mask:0xc
    v_fma_f32 v42, -v40, v40, v42
    v_add_f32_dpp v38, v35, v35 row_mirror row_mask:0xf bank_mask:0xc
    v_max_f32 v42, 0, v42
    v_add_f32_dpp v36, v37, v37 row_half_mirror row_mask:0xf bank_mask:0x5
    v_add_f32 v42, 0x3727c5ac, v42
    v_rsq_f32 v42, v42
    v_add_f32_dpp v36, v38, v38 row_half_mirror row_mask:0xf bank_mask:0xa
    v_mul_f32 v40, v40, v56
    v_fma_f32 v60, -v40, v42, v60
    v_add_f32_dpp v36, v36, v36 quad_perm:[1,0,3,2] row_mask:0xf bank_mask:0xf
    s_nop 1
    v_add_f32_dpp v36, v36, v36 quad_perm:[2,3,0,1] row_mask:0xf bank_mask:0xf
    v_fma_f32 v36, v36, v42, v60
    v_max_f32 v36, 0, v36
    v_mul_f32 v36, v36, v36
    v_cvt_pk_bf16_f32 v36, v36, v36
    ds_write_b32 v62, v36 offset:12288
    s_waitcnt lgkmcnt(0)
    s_barrier
    s_endpgm
L_R7:
    s_setprio 0
    s_cmp_ge_u32 s27, 2
    s_cbranch_scc1 L_Z
L_R:
    v_mov_b32 v14, 0xff
    s_cmp_eq_u32 s27, 3
    s_cbranch_scc1 L_T
    v_lshrrev_b32 v5, 5, v1
    v_lshrrev_b32 v44, 3, v1
    v_and_b32 v45, 7, v1
    v_bfe_u32 v6, v1, 2, 1
    v_lshlrev_b32 v2, 4, v5
    v_lshrrev_b32 v112, v2, s32
    v_lshrrev_b32 v113, 8, v112
    v_and_b32 v7, 16, v1
    v_lshl_add_u32 v7, v5, 3, v7
    s_mov_b32 s14, 0x00ff00ff
    s_mov_b32 s15, 0x00ff00ff
    s_cmp_eq_u32 s27, 0
    s_cbranch_scc1 L_F2
    s_mul_i32 s38, s40, 0x1c000
    s_lshl_b32 s39, s91, 9
    s_add_u32 s38, s38, s39
    s_lshl_b32 s39, s45, 7
    s_add_u32 s38, s38, s39
    s_add_u32 s16, s16, s38
    s_addc_u32 s17, s17, 0
    v_mul_u32_u24 v56, 14336, v44
    v_lshl_add_u32 v56, v45, 4, v56
    v_add_u32 v57, 7168, v56
    v_lshl_add_u32 v63, v44, 2, v6
    s_lshl_b32 s38, s40, 6
    v_lshl_add_u32 v60, v63, 1, s38
    v_mov_b32 v2, 0
L_bh:
    ds_read_b128 v[32:35], v2 offset:1488
    s_sub_u32 s36, s36, 1
    s_cbranch_scc1 L_end
    s_waitcnt lgkmcnt(0)
    v_and_b32 v32, v32, v33
    v_bitop3_b32 v32, v32, v34, v35 bitop3:0x80
    v_cmp_ne_u32 vcc, 0xff, v32
    s_cbranch_vccnz L_bh
    global_load_dwordx4 v[80:83], v56, s[16:17] offset:0 nt
    global_load_dwordx4 v[84:87], v56, s[16:17] offset:3584 nt
    global_load_dwordx4 v[88:91], v57, s[16:17] offset:0 nt
    global_load_dwordx4 v[92:95], v57, s[16:17] offset:3584 nt
    s_barrier
    global_load_ushort v58, v60, s[4:5]
    global_load_ushort v59, v60, s[4:5] offset:4
    v_and_b32 v2, 1, v1
    v_lshlrev_b32 v2, 4, v2
    v_mov_b32 v3, 0xffff
    v_lshlrev_b32 v2, v2, v3
    v_bfe_u32 v3, v1, 1, 2
    v_cmp_eq_u32 vcc, 0, v3
    s_nop 1
    v_cndmask_b32 v16, 0, v2, vcc
    v_cmp_eq_u32 vcc, 1, v3
    s_nop 1
    v_cndmask_b32 v17, 0, v2, vcc
    v_cmp_eq_u32 vcc, 2, v3
    s_nop 1
    v_cndmask_b32 v18, 0, v2, vcc
    v_cmp_eq_u32 vcc, 3, v3
    s_nop 1
    v_cndmask_b32 v19, 0, v2, vcc
    v_lshlrev_b32 v63, 4, v63
    s_mul_i32 s38, s91, 0x9000
    s_lshl_b32 s39, s45, 13
    s_add_u32 s38, s38, s39
    s_lshl_b32 s39, s40, 6
    s_add_u32 s38, s38, s39
    s_add_u32 s38, s38, 0x110000
    s_add_u32 s8, s28, s38
    s_addc_u32 s9, s29, 0
    v_lshrrev_b32 v13, 1, v45
    v_lshl_add_u32 v13, v13, 11, v7
    v_and_b32 v2, 1, v45
    v_lshl_add_u32 v13, v2, 5, v13
    v_and_b32 v2, 8, v1
    v_cmp_eq_u32 vcc, 0, v2
    v_lshl_add_u32 v2, v4, 3, v45
    s_lshl_b32 s38, s40, 4
    s_lshl_b32 s39, s45, 3
    s_add_u32 s38, s38, s39
    s_add_u32 s38, s38, 0x8000
    v_lshl_add_u32 v2, v2, 8, s38
    s_lshl_b32 s38, s45, 13
    s_lshl_b32 s39, s40, 6
    s_add_u32 s38, s38, s39
    v_subrev_u32 v2, s38, v2
    v_cndmask_b32 v114, v2, v13, vcc
    v_cndmask_b32 v117, -1, v14, vcc
    v_mov_b32_e64 v2, s32
    v_cndmask_b32 v113, v2, v113, vcc
    v_mov_b32 v118, 0x3f803f80
    v_mov_b32 v119, 0x3b000000
    s_bfe_i32 s44, s45, 0x10000
    s_cmp_lt_u32 s45, 2
    s_mov_b32 s10, 0xffffff
    s_cselect_b32 s10, s10, 0x00ff00ff
    s_mov_b32 s11, 0x00ff00ff
    v_and_b32 v24, v118, v16
    v_and_b32 v25, v118, v17
    v_and_b32 v26, v118, v18
    v_and_b32 v27, v118, v19
    ds_read_b32 v2, v23 offset:1516
    s_waitcnt vmcnt(5)
    s_barrier
    s_nop 0
    s_waitcnt vmcnt(2) lgkmcnt(0)
    v_readfirstlane_b32 s37, v2
    v_mfma_f32_16x16x32_bf16 v[20:23], v[24:27], v[80:83], 0
    v_mfma_f32_16x16x32_bf16 v[20:23], v[24:27], v[84:87], v[20:23]
    v_mfma_f32_16x16x32_bf16 v[20:23], v[24:27], v[88:91], v[20:23]
    v_mfma_f32_16x16x32_bf16 v[20:23], v[24:27], v[92:95], v[20:23]
    s_bitcmp0_b32 s37, 1
    s_cbranch_scc1 L_slow3
    s_nop 5
    v_permlane32_swap_b32 v20, v22
    v_permlane32_swap_b32 v21, v23
    s_nop 0
    v_add_f32_dpp v20, v22, v20 row_ror:8 row_mask:0xf bank_mask:0xf
    v_add_f32_dpp v21, v23, v21 row_ror:8 row_mask:0xf bank_mask:0xf
    s_mov_b64 exec, s[14:15]
    v_bfi_b32 v20, v14, v112, v20
    v_bfi_b32 v21, v14, v113, v21
    global_store_dwordx2 v13, v[20:21], s[8:9] offset:1024
    s_mov_b64 exec, -1
    s_waitcnt vmcnt(1)
    v_lshlrev_b32 v58, 16, v58
    v_lshlrev_b32 v59, 16, v59
    s_barrier
    ds_read_b128 v[36:39], v63 offset:12288
    ds_read_b128 v[40:43], v63 offset:12320
    s_waitcnt lgkmcnt(1)
    v_pk_add_f32 v[36:37], v[36:37], v[38:39]
    v_add_f32 v36, v36, v37
    v_add_f32 v36, v36, v58
    v_cvt_pk_bf16_f32 v38, v36, v36
    s_waitcnt lgkmcnt(0)
    v_pk_add_f32 v[40:41], v[40:41], v[42:43]
    v_add_f32 v37, v40, v41
    v_add_f32 v37, v37, v59
    v_cvt_pk_bf16_f32 v39, v37, v37
    v_and_b32_dpp v24, v38, v16 quad_perm:[0,1,2,3] row_mask:0xf bank_mask:0xf
    v_and_b32_dpp v25, v38, v17 quad_perm:[0,1,2,3] row_mask:0xf bank_mask:0xf
    v_and_b32_dpp v26, v38, v18 row_half_mirror row_mask:0xf bank_mask:0xf
    v_and_b32_dpp v27, v38, v19 row_half_mirror row_mask:0xf bank_mask:0xf
    v_and_b32_dpp v28, v38, v16 row_half_mirror row_mask:0xf bank_mask:0xf
    v_and_b32_dpp v29, v38, v17 row_half_mirror row_mask:0xf bank_mask:0xf
    v_cvt_pk_bf16_f32 v40, v36, v37
    v_bfi_b32 v41, s44, v40, v118
    v_dot2_f32_bf16 v42, v40, v41, 0
    v_mfma_f32_16x16x32_bf16 v[20:23], v[24:27], v[80:83], 0
    v_and_b32_dpp v30, v38, v18 quad_perm:[0,1,2,3] row_mask:0xf bank_mask:0xf
    v_and_b32_dpp v31, v38, v19 quad_perm:[0,1,2,3] row_mask:0xf bank_mask:0xf
    v_and_b32_dpp v24, v39, v16 quad_perm:[0,1,2,3] row_mask:0xf bank_mask:0xf
    v_and_b32_dpp v25, v39, v17 quad_perm:[0,1,2,3] row_mask:0xf bank_mask:0xf
    v_mfma_f32_16x16x32_bf16 v[20:23], v[28:31], v[84:87], v[20:23]
    v_and_b32_dpp v26, v39, v18 row_half_mirror row_mask:0xf bank_mask:0xf
    v_and_b32_dpp v27, v39, v19 row_half_mirror row_mask:0xf bank_mask:0xf
    v_and_b32_dpp v28, v39, v16 row_half_mirror row_mask:0xf bank_mask:0xf
    v_and_b32_dpp v29, v39, v17 row_half_mirror row_mask:0xf bank_mask:0xf
    v_mfma_f32_16x16x32_bf16 v[20:23], v[24:27], v[88:91], v[20:23]
    v_and_b32_dpp v30, v39, v18 quad_perm:[0,1,2,3] row_mask:0xf bank_mask:0xf
    v_and_b32_dpp v31, v39, v19 quad_perm:[0,1,2,3] row_mask:0xf bank_mask:0xf
    v_add_f32_dpp v42, v42, v42 row_half_mirror row_mask:0xf bank_mask:0xf
    s_nop 0
    v_mfma_f32_16x16x32_bf16 v[20:23], v[28:31], v[92:95], v[20:23]
    v_add_f32_dpp v41, v42, v42 row_mirror row_mask:0xf bank_mask:0xf
    v_add_f32_dpp v42, v42, v42 row_mirror row_mask:0xf bank_mask:0xf
    s_nop 1
    v_permlane16_swap_b32 v41, v42
    v_add_f32 v42, v42, v41
    v_mov_b32 v41, v42
    s_nop 0
    v_permlane32_swap_b32 v20, v22
    v_permlane32_swap_b32 v41, v42
    v_add_f32 v42, v42, v41
    v_permlane32_swap_b32 v21, v23
    v_add_f32_dpp v20, v22, v20 row_ror:8 row_mask:0xf bank_mask:0xf
    v_bfi_b32 v20, v14, v112, v20
    v_add_f32_dpp v21, v23, v21 row_ror:8 row_mask:0xf bank_mask:0xf
    v_bfi_b32 v21, v117, v113, v21
    v_mul_f32_dpp v20, v42, v119 quad_perm:[0,1,2,3] row_mask:0xf bank_mask:0xc
    s_mov_b64 exec, s[10:11]
    global_store_dwordx2 v114, v[20:21], s[8:9]
    s_branch L_S2
L_F2:
    s_lshl_b32 s38, s91, 4
    s_add_u32 s41, s38, s40
    s_lshr_b32 s41, s41, 1
    s_and_b32 s57, s40, 1
    s_lshl_b32 s38, s41, 15
    s_lshl_b32 s39, s57, 9
    s_add_u32 s38, s38, s39
    s_lshl_b32 s39, s45, 7
    s_add_u32 s38, s38, s39
    s_add_u32 s20, s20, s38
    s_addc_u32 s21, s21, 0
    v_bfe_u32 v2, v1, 3, 1
    v_lshl_add_u32 v2, v2, 2, v4
    v_lshlrev_b32 v56, 12, v2
    v_lshl_add_u32 v56, v45, 4, v56
    v_lshlrev_b32 v60, 4, v2
    s_and_b32 s56, s40, 14
    s_mul_i32 s38, s91, 0x9000
    s_lshl_b32 s39, s56, 11
    s_add_u32 s38, s38, s39
    s_add_u32 s38, s38, 0x110000
    s_add_u32 s6, s28, s38
    s_addc_u32 s7, s29, 0
    s_lshr_b32 s59, s40, 1
    s_mul_i32 s38, s91, 0x9000
    s_lshl_b32 s39, s59, 8
    s_add_u32 s38, s38, s39
    s_add_u32 s38, s38, 0x118000
    s_add_u32 s8, s28, s38
    s_addc_u32 s9, s29, 0
    s_lshl_b32 s38, s45, 9
    s_lshl_b32 s39, s57, 11
    s_add_u32 s38, s38, s39
    v_lshl_add_u32 v8, v1, 7, s38
    s_lshl_b32 s38, s45, 6
    v_mov_b32 v9, s38
    s_barrier
    s_mov_b64 exec, 15
    global_load_dword v125, v8, s[6:7] sc1
    global_load_dword v124, v9, s[8:9] sc1
    s_mov_b64 exec, -1
    global_load_dwordx4 v[80:83], v56, s[20:21] offset:0 nt
    global_load_dwordx4 v[84:87], v56, s[20:21] offset:1024 nt
    global_load_dwordx4 v[88:91], v56, s[20:21] offset:2048 nt
    global_load_dwordx4 v[92:95], v56, s[20:21] offset:3072 nt
    s_barrier
    v_and_b32 v2, 1, v1
    v_lshlrev_b32 v2, 4, v2
    v_mov_b32 v3, 0xffff
    v_lshlrev_b32 v2, v2, v3
    v_bfe_u32 v3, v1, 1, 2
    v_cmp_eq_u32 vcc, 0, v3
    s_nop 1
    v_cndmask_b32 v16, 0, v2, vcc
    v_cmp_eq_u32 vcc, 1, v3
    s_nop 1
    v_cndmask_b32 v17, 0, v2, vcc
    v_cmp_eq_u32 vcc, 2, v3
    s_nop 1
    v_cndmask_b32 v18, 0, v2, vcc
    v_cmp_eq_u32 vcc, 3, v3
    s_nop 1
    v_cndmask_b32 v19, 0, v2, vcc
    s_lshl_b32 s38, s57, 16
    s_lshl_b32 s39, s45, 14
    s_add_u32 s38, s38, s39
    s_lshl_b32 s39, s41, 7
    s_add_u32 s38, s38, s39
    s_add_u32 s38, s38, 0x180000
    s_add_u32 s10, s28, s38
    s_addc_u32 s11, s29, 0
    v_lshl_add_u32 v62, v6, 13, v7
    v_and_b32 v2, 3, v1
    v_lshl_add_u32 v62, v2, 5, v62
    v_not_b32 v63, v112
    s_waitcnt vmcnt(0)
    s_barrier
    global_store_dword v62, v63, s[10:11] sc1
    s_barrier
    ds_read_b128 v[32:35], v60 offset:12288
    s_waitcnt lgkmcnt(0)
    v_and_b32 v24, v32, v16
    v_and_b32 v25, v32, v17
    v_and_b32 v26, v32, v18
    v_and_b32 v27, v32, v19
    v_and_b32 v28, v33, v16
    v_and_b32 v29, v33, v17
    v_mfma_f32_16x16x32_bf16 v[20:23], v[24:27], v[80:83], 0
    v_and_b32 v30, v33, v18
    v_and_b32 v31, v33, v19
    v_and_b32 v24, v34, v16
    v_and_b32 v25, v34, v17
    v_mfma_f32_16x16x32_bf16 v[20:23], v[28:31], v[84:87], v[20:23]
    v_and_b32 v26, v34, v18
    v_and_b32 v27, v34, v19
    v_and_b32 v28, v35, v16
    v_and_b32 v29, v35, v17
    v_mfma_f32_16x16x32_bf16 v[20:23], v[24:27], v[88:91], v[20:23]
    v_and_b32 v30, v35, v18
    v_and_b32 v31, v35, v19
    s_nop 1
    v_mfma_f32_16x16x32_bf16 v[20:23], v[28:31], v[92:95], v[20:23]
    s_nop 7
    v_permlane32_swap_b32 v20, v22
    v_permlane32_swap_b32 v21, v23
    s_nop 0
    v_add_f32_dpp v20, v22, v20 row_ror:8 row_mask:0xf bank_mask:0xf
    v_add_f32_dpp v21, v23, v21 row_ror:8 row_mask:0xf bank_mask:0xf
    s_mov_b64 exec, s[14:15]
    v_bfi_b32 v20, v14, v112, v20
    v_bfi_b32 v21, v14, v113, v21
    global_store_dwordx2 v62, v[20:21], s[10:11] sc1
    s_endpgm
L_T:
    s_barrier
L_fin:
    s_setprio 0
    s_lshl_b32 s38, s40, 13
    s_lshl_b32 s39, s3, 10
    s_add_u32 s38, s38, s39
    s_add_u32 s38, s38, 0x180000
    s_add_u32 s48, s28, s38
    s_addc_u32 s49, s29, 0
    v_lshlrev_b32 v8, 4, v1
    v_and_b32 v9, 7, v1
    v_lshl_add_u32 v9, v9, 2, v4
    s_lshl_b32 s38, s3, 2
    v_lshl_add_u32 v9, v9, 5, s38
    s_lshl_b32 s38, s40, 6
    v_lshl_add_u32 v6, v1, 1, s38
    v_mov_b32 v10, 0
    v_lshlrev_b32 v11, 5, v1
    s_waitcnt vmcnt(0)
    s_barrier
L_p4:
    global_load_dwordx4 v[32:35], v8, s[48:49] sc1
    s_sub_u32 s36, s36, 1
    s_cbranch_scc1 L_end
    s_waitcnt vmcnt(0)
    v_xor_b32 v32, s43, v32
    v_xor_b32 v33, s33, v33
    v_xor_b32 v34, s34, v34
    v_xor_b32 v35, s35, v35
    v_or3_b32 v44, v32, v33, v34
    v_bitop3_b32 v44, v44, v35, v14 bitop3:0xa8
    v_cmp_ne_u32 vcc, 0, v44
    v_permlane32_swap_b32 v32, v34
    v_permlane32_swap_b32 v33, v35
    v_pk_add_f32 v[32:33], v[32:33], v[34:35]
    s_cbranch_vccnz L_p4
    s_nop 0
    v_permlane16_swap_b32 v32, v33
    v_add_f32 v32, v32, v33
    s_nop 1
    v_add_f32_dpp v32, v32, v32 row_ror:8 row_mask:0xf bank_mask:0xf
L_la:
    ds_write_b32 v9, v32 offset:12800
    s_mov_b64 exec, 1
    ds_add_rtn_u32 v40, v10, v14 offset:1476
    s_mov_b32 exec_lo, -1
    ds_read_b128 v[32:35], v11 offset:12800
    ds_read_b128 v[36:39], v11 offset:12816
    s_waitcnt lgkmcnt(2)
    v_readfirstlane_b32 s38, v40
    s_waitcnt lgkmcnt(1)
    v_pk_add_f32 v[32:33], v[32:33], v[34:35]
    s_cmp_lg_u32 s38, 1785
    s_cbranch_scc1 L_end
    s_waitcnt lgkmcnt(0)
    v_pk_add_f32 v[36:37], v[36:37], v[38:39]
    v_pk_add_f32 v[32:33], v[32:33], v[36:37]
    v_add_f32 v32, v32, v33
    v_cvt_pk_bf16_f32 v32, v32, v32
    global_store_short v6, v32, s[24:25]
    s_endpgm
.fill 30, 4, 0xbf810000
L_Z:
    s_cmp_lg_u32 s27, 3
    s_cbranch_scc1 L_end
    s_lshl_b32 s38, s40, 6
    s_mov_b32 exec_hi, 0
    v_lshl_add_u32 v6, v1, 1, s38
    v_lshlrev_b32 v7, 2, v1
    v_lshlrev_b32 v8, 5, v1
    s_lshl_b32 s38, s40, 7
    s_add_u32 s38, s38, 0x160000
    s_add_u32 s46, s28, s38
    s_addc_u32 s47, s29, 0
    v_and_b32 v2, 1, v1
    v_lshlrev_b32 v2, 4, v2
    v_lshrrev_b32 v27, v2, s32
    v_and_b32 v27, 0xffff, v27
    s_barrier
    s_barrier
    global_load_ushort v25, v6, s[22:23]
L_ph:
    global_load_dword v24, v7, s[46:47] sc1
    s_sub_u32 s36, s36, 1
    s_cbranch_scc1 L_end
    s_waitcnt vmcnt(0)
    v_xor_b32 v24, v24, v27
    v_and_b32 v2, 0xffff, v24
    v_cmp_ne_u32 vcc, 0, v2
    s_cbranch_vccnz L_ph
    v_lshlrev_b32 v25, 16, v25
    v_add_f32 v32, v25, v24
    v_add_u32 v9, 28, v8
    v_mov_b32 v10, 0
    v_mov_b32 v11, v8
    v_mov_b32 v14, 0xff
    s_branch L_la
    s_endpgm
L_end:
L_exit:
    s_endpgm
L_slow0:
    s_waitcnt vmcnt(0)
    v_swap_b32 v90, v92
    v_swap_b32 v91, v93
    v_mov_b32 v51, s32
    v_mov_b32 v55, s32
    v_mfma_f32_16x16x32_bf16 v[24:27], v[44:47], v[88:91], v[24:27]
    v_mfma_f32_16x16x32_bf16 v[28:31], v[44:47], v[92:95], v[28:31]
    s_nop 0
    s_waitcnt lgkmcnt(3)
    v_pk_fma_f32 v[116:117], v[56:57], v[108:109], v[116:117] op_sel:[0,1,0] op_sel_hi:[1,1,1]
    v_pk_fma_f32 v[118:119], v[58:59], v[108:109], v[118:119] op_sel:[0,1,0] op_sel_hi:[1,1,1]
    v_pk_fma_f32 v[120:121], v[60:61], v[108:109], v[120:121] op_sel:[0,1,0] op_sel_hi:[1,1,1]
    v_pk_fma_f32 v[122:123], v[62:63], v[108:109], v[122:123] op_sel:[0,1,0] op_sel_hi:[1,1,1]
    s_nop 0
    s_waitcnt lgkmcnt(0)
    v_pk_fma_f32 v[116:117], v[96:97], v[110:111], v[116:117] op_sel:[0,0,0] op_sel_hi:[1,0,1]
    v_pk_fma_f32 v[118:119], v[98:99], v[110:111], v[118:119] op_sel:[0,0,0] op_sel_hi:[1,0,1]
    v_pk_fma_f32 v[116:117], v[24:25], v[110:111], v[116:117] op_sel:[0,1,0] op_sel_hi:[1,1,1]
    v_pk_fma_f32 v[118:119], v[26:27], v[110:111], v[118:119] op_sel:[0,1,0] op_sel_hi:[1,1,1]
    v_cvt_pk_bf16_f32 v48, v116, v117
    v_cvt_pk_bf16_f32 v49, v118, v119
    global_store_dwordx4 v20, v[48:51], s[46:47] sc1
    v_pk_fma_f32 v[120:121], v[100:101], v[110:111], v[120:121] op_sel:[0,0,0] op_sel_hi:[1,0,1]
    v_pk_fma_f32 v[122:123], v[102:103], v[110:111], v[122:123] op_sel:[0,0,0] op_sel_hi:[1,0,1]
    v_pk_fma_f32 v[120:121], v[28:29], v[110:111], v[120:121] op_sel:[0,1,0] op_sel_hi:[1,1,1]
    v_pk_fma_f32 v[122:123], v[30:31], v[110:111], v[122:123] op_sel:[0,1,0] op_sel_hi:[1,1,1]
    v_pk_mul_f32 v[104:105], v[104:105], v[108:109]
    v_pk_fma_f32 v[104:105], v[106:107], v[110:111], v[104:105]
    v_cvt_pk_bf16_f32 v52, v120, v121
    v_cvt_pk_bf16_f32 v53, v122, v123
    v_add_f32 v54, v104, v105
    global_store_dwordx4 v20, v[52:55], s[46:47] offset:2048 sc1
    s_barrier
    s_branch L_R7
    s_nop 0
L_p1:
    global_load_dwordx4 v[32:35], v7, s[46:47] offset:-4096 sc1
    global_load_dwordx4 v[36:39], v7, s[46:47] sc1
    global_load_dwordx4 v[64:67], v47, s[12:13] offset:0 nt
    global_load_dwordx4 v[68:71], v47, s[12:13] offset:1024 nt
    global_load_dwordx4 v[72:75], v47, s[12:13] offset:2048 nt
    global_load_dwordx4 v[76:79], v47, s[12:13] offset:3072 nt
    s_movk_i32 s44, 0x4000
    s_waitcnt vmcnt(5)
    v_xor_b32 v32, s43, v32
    v_xor_b32 v33, s33, v33
    v_xor_b32 v34, s34, v34
    v_xor_b32 v35, s35, v35
    v_or3_b32 v42, v32, v33, v34
    s_waitcnt vmcnt(4)
    v_xor_b32 v36, s43, v36
    v_xor_b32 v37, s33, v37
    v_xor_b32 v38, s34, v38
    v_xor_b32_e64 v39, s35, v39
    v_or3_b32 v42, v42, v35, v36
    v_or3_b32 v42, v42, v37, v38
    v_bitop3_b32 v42, v42, v39, v14 bitop3:0xa8
    v_cmp_ne_u32 vcc, 0, v42
    v_pk_add_f32 v[32:33], v[32:33], v[36:37]
    v_pk_add_f32 v[34:35], v[34:35], v[38:39]
    s_nop 1
    v_permlane32_swap_b32 v32, v34
    v_permlane32_swap_b32 v33, v35
    v_pk_add_f32 v[32:33], v[32:33], v[34:35]
    v_cvt_pk_bf16_f32 v43, v32, v33
    ds_write_b32 v10, v43 offset:0
    s_cbranch_vccz L_p1ok
L_p1r:
    v_xor_b32 v7, s44, v7
    global_load_dwordx4 v[32:35], v7, s[46:47] offset:-4096 sc1
    global_load_dwordx4 v[36:39], v7, s[46:47] sc1
    s_sub_u32 s36, s36, 1
    s_cbranch_scc1 L_end
    s_waitcnt vmcnt(1)
    v_xor_b32 v32, s43, v32
    v_xor_b32 v33, s33, v33
    v_xor_b32 v34, s34, v34
    v_xor_b32 v35, s35, v35
    v_or3_b32 v42, v32, v33, v34
    s_waitcnt vmcnt(0)
    v_xor_b32 v36, s43, v36
    v_xor_b32 v37, s33, v37
    v_xor_b32 v38, s34, v38
    v_xor_b32 v39, s35, v39
    v_or3_b32 v42, v42, v35, v36
    v_or3_b32 v42, v42, v37, v38
    v_bitop3_b32 v42, v42, v39, v14 bitop3:0xa8
    v_cmp_ne_u32 vcc, 0, v42
    v_pk_add_f32 v[32:33], v[32:33], v[36:37]
    v_pk_add_f32 v[34:35], v[34:35], v[38:39]
    s_nop 1
    v_permlane32_swap_b32 v32, v34
    v_permlane32_swap_b32 v33, v35
    v_pk_add_f32 v[32:33], v[32:33], v[34:35]
    v_cvt_pk_bf16_f32 v43, v32, v33
    ds_write_b32 v10, v43 offset:0
    s_cbranch_vccnz L_p1r
    s_branch L_p1ok
L_xcr:
    v_xor_b32 v6, 0x4000, v6
    global_load_dwordx2 v[40:41], v6, s[46:47] sc1
    s_sub_u32 s36, s36, 1
    s_cbranch_scc1 L_end
    s_waitcnt vmcnt(0)
    s_branch L_xc
L_slow3:
    s_nop 7
    v_permlane32_swap_b32 v20, v22
    v_permlane32_swap_b32 v21, v23
    s_nop 0
    v_add_f32_dpp v20, v22, v20 row_ror:8 row_mask:0xf bank_mask:0xf
    v_add_f32_dpp v21, v23, v21 row_ror:8 row_mask:0xf bank_mask:0xf
    s_mov_b64 exec, s[14:15]
    v_bfi_b32 v20, v14, v112, v20
    v_bfi_b32 v21, v14, v113, v21
    global_store_dwordx2 v13, v[20:21], s[8:9] offset:1024 sc1
    s_mov_b64 exec, -1
    s_waitcnt vmcnt(1)
    v_lshlrev_b32 v58, 16, v58
    v_lshlrev_b32 v59, 16, v59
    s_barrier
    ds_read_b128 v[36:39], v63 offset:12288
    ds_read_b128 v[40:43], v63 offset:12320
    s_waitcnt lgkmcnt(1)
    v_pk_add_f32 v[36:37], v[36:37], v[38:39]
    v_add_f32 v36, v36, v37
    v_add_f32 v36, v36, v58
    v_cvt_pk_bf16_f32 v38, v36, v36
    s_waitcnt lgkmcnt(0)
    v_pk_add_f32 v[40:41], v[40:41], v[42:43]
    v_add_f32 v37, v40, v41
    v_add_f32 v37, v37, v59
    v_cvt_pk_bf16_f32 v39, v37, v37
    v_and_b32_dpp v24, v38, v16 quad_perm:[0,1,2,3] row_mask:0xf bank_mask:0xf
    v_and_b32_dpp v25, v38, v17 quad_perm:[0,1,2,3] row_mask:0xf bank_mask:0xf
    v_and_b32_dpp v26, v38, v18 row_half_mirror row_mask:0xf bank_mask:0xf
    v_and_b32_dpp v27, v38, v19 row_half_mirror row_mask:0xf bank_mask:0xf
    v_and_b32_dpp v28, v38, v16 row_half_mirror row_mask:0xf bank_mask:0xf
    v_and_b32_dpp v29, v38, v17 row_half_mirror row_mask:0xf bank_mask:0xf
    v_cvt_pk_bf16_f32 v40, v36, v37
    v_bfi_b32 v41, s44, v40, v118
    v_dot2_f32_bf16 v42, v40, v41, 0
    v_mfma_f32_16x16x32_bf16 v[20:23], v[24:27], v[80:83], 0
    v_and_b32_dpp v30, v38, v18 quad_perm:[0,1,2,3] row_mask:0xf bank_mask:0xf
    v_and_b32_dpp v31, v38, v19 quad_perm:[0,1,2,3] row_mask:0xf bank_mask:0xf
    v_and_b32_dpp v24, v39, v16 quad_perm:[0,1,2,3] row_mask:0xf bank_mask:0xf
    v_and_b32_dpp v25, v39, v17 quad_perm:[0,1,2,3] row_mask:0xf bank_mask:0xf
    v_mfma_f32_16x16x32_bf16 v[20:23], v[28:31], v[84:87], v[20:23]
    v_and_b32_dpp v26, v39, v18 row_half_mirror row_mask:0xf bank_mask:0xf
    v_and_b32_dpp v27, v39, v19 row_half_mirror row_mask:0xf bank_mask:0xf
    v_and_b32_dpp v28, v39, v16 row_half_mirror row_mask:0xf bank_mask:0xf
    v_and_b32_dpp v29, v39, v17 row_half_mirror row_mask:0xf bank_mask:0xf
    v_mfma_f32_16x16x32_bf16 v[20:23], v[24:27], v[88:91], v[20:23]
    v_and_b32_dpp v30, v39, v18 quad_perm:[0,1,2,3] row_mask:0xf bank_mask:0xf
    v_and_b32_dpp v31, v39, v19 quad_perm:[0,1,2,3] row_mask:0xf bank_mask:0xf
    v_add_f32_dpp v42, v42, v42 row_half_mirror row_mask:0xf bank_mask:0xf
    s_nop 0
    v_mfma_f32_16x16x32_bf16 v[20:23], v[28:31], v[92:95], v[20:23]
    v_add_f32_dpp v41, v42, v42 row_mirror row_mask:0xf bank_mask:0xf
    v_add_f32_dpp v42, v42, v42 row_mirror row_mask:0xf bank_mask:0xf
    s_nop 1
    v_permlane16_swap_b32 v41, v42
    v_add_f32 v42, v42, v41
    v_mov_b32 v41, v42
    s_nop 0
    v_permlane32_swap_b32 v20, v22
    v_permlane32_swap_b32 v41, v42
    v_add_f32 v42, v42, v41
    v_permlane32_swap_b32 v21, v23
    v_add_f32_dpp v20, v22, v20 row_ror:8 row_mask:0xf bank_mask:0xf
    v_bfi_b32 v20, v14, v112, v20
    v_add_f32_dpp v21, v23, v21 row_ror:8 row_mask:0xf bank_mask:0xf
    v_bfi_b32 v21, v117, v113, v21
    v_mul_f32_dpp v20, v42, v119 quad_perm:[0,1,2,3] row_mask:0xf bank_mask:0xc
    s_mov_b64 exec, s[10:11]
    global_store_dwordx2 v114, v[20:21], s[8:9] sc1
    s_branch L_S2
L_S2:
    s_and_b32 s38, s40, 3
    s_cmp_lg_u32 s38, s91
    s_cbranch_scc1 L_end
    s_cmp_lg_u32 s45, 2
    s_cbranch_scc1 L_end
    s_mov_b64 exec, -1
    s_lshl_b32 s38, s40, 7
    s_add_u32 s38, s38, 0x160000
    s_add_u32 s20, s28, s38
    s_addc_u32 s21, s29, 0
    v_and_b32 v2, 1, v1
    v_cmp_eq_u32 vcc, 1, v2
    v_lshrrev_b32 v3, 2, v63
    v_lshl_add_u32 v3, v2, 3, v3
    v_lshlrev_b32 v2, 4, v6
    v_lshrrev_b32 v2, v2, s32
    v_cndmask_b32 v38, v38, v39, vcc
    v_bfi_b32 v38, s58, v38, v2
    s_barrier
    global_store_dword v3, v38, s[20:21] sc1
    s_cmp_lg_u32 s40, 0
    s_cbranch_scc1 L_end
    v_mov_b32 v41, 0
    v_mov_b32 v42, s32
    global_store_dword v41, v42, s[28:29] sc1
    s_endpgm
.p2align 12, 0
.section .rodata,"a"
.p2align 6
.amdhsa_kernel sequential_preLN__sliding_block_cached__dense_activation_squared_relu__decode_kernel
  .amdhsa_next_free_vgpr 128
  .amdhsa_next_free_sgpr 96
  .amdhsa_accum_offset 128
  .amdhsa_group_segment_fixed_size 0
  .amdhsa_kernarg_size 104
  .amdhsa_user_sgpr_count 2
  .amdhsa_user_sgpr_kernarg_segment_ptr 1
  .amdhsa_system_sgpr_workgroup_id_x 1
  .amdhsa_float_denorm_mode_32 3
.end_amdhsa_kernel
```
